```python
import torch

def _softmax(x, axis=-1):
    return torch.softmax(x, dim=axis)
def _gelu(x):
    return torch.nn.functional.gelu(x, approximate="tanh")
def _silu(x):
    return torch.nn.functional.silu(x)
def _sigmoid(x):
    return torch.sigmoid(x)
def _layernorm(x, axis=-1, eps=1e-5):
    m = x.mean(dim=axis, keepdim=True)
    v = x.var(dim=axis, keepdim=True, unbiased=False)
    return (x - m) / torch.sqrt(v + eps)
def _scatter_add(tgt, idx, src, axis=0):
    return tgt.clone().index_add_(axis, idx, src)
def _segment_sum(src, seg, n):
    out = torch.zeros((n,) + src.shape[1:], dtype=src.dtype)
    return out.index_add_(0, seg, src)
def _pad(x, pw):
    flat = tuple(v for pair in reversed(pw) for v in pair)
    return torch.nn.functional.pad(x, flat)

kernel_name = 'gather_scatter__mpnn_edge_mlp__graph'

def setup_inputs():

    _w = (lambda a: (lambda t: t.to(torch.bfloat16) if t.is_floating_point() else t)(torch.as_tensor(a)))
    N, deg, D, De = 10000, 32, 128, max(4, 1)
    E = N * deg
    return {
        "x": _w((lambda *s: torch.randn(*s, dtype=torch.bfloat16) * 0.05)(N, D)),
        "e_attr": _w((lambda *s: torch.randn(*s, dtype=torch.bfloat16) * 0.4)(E, De)),
        "src": _w((lambda lo, hi, *s: torch.randint(lo, hi, s))(0, N, E).to(torch.int64)),
        "dst": _w((lambda lo, hi, *s: torch.randint(lo, hi, s))(0, N, E).to(torch.int64)),
        "w_msg": _w((lambda *s: torch.randn(*s, dtype=torch.bfloat16) * 0.4)(2 * D + De, D)),
        "w_upd": _w((lambda *s: torch.randn(*s, dtype=torch.bfloat16) * 0.05)(2 * D, D)),
    }

def reference(x, e_attr, src, dst, w_msg, w_upd):
    N, D = x.shape
    m_in = torch.concatenate([x[src], x[dst], e_attr], axis=-1)
    msg = _silu(m_in @ w_msg)
    agg = _segment_sum(msg, dst, N)
    return _silu(torch.concatenate([x, agg], axis=-1) @ w_upd)
```

```asm
; @launch grid=(256,1,1) block=(1024,1,1) lds=159488
.amdgcn_target "amdgcn-amd-amdhsa--gfx950"
.text
.globl gather_scatter__mpnn_edge_mlp__graph_kernel
.p2align 8
.type gather_scatter__mpnn_edge_mlp__graph_kernel,@function
gather_scatter__mpnn_edge_mlp__graph_kernel:
    s_load_dwordx16 s[4:19], s[0:1], 0
    s_load_dwordx2 s[20:21], s[0:1], 64
    s_cmp_ge_u32 s2, 256
    s_cbranch_scc1 K_END
    v_mov_b32 v108, v0
    v_lshrrev_b32 v1, 6, v0
    v_and_b32 v97, 63, v0
    v_readfirstlane_b32 s22, v1
    s_and_b32 s49, s2, 7
    s_lshl_b32 s49, s49, 5
    s_lshr_b32 s3, s2, 3
    s_or_b32 s49, s49, s3
    v_lshrrev_b32 v126, 4, v97
    v_and_b32 v127, 15, v97
    s_mul_i32 s3, s49, 625
    s_add_u32 s23, s3, 15
    s_lshr_b32 s23, s23, 4
    s_add_u32 s62, s3, 640
    s_lshr_b32 s62, s62, 4
    v_mov_b32 v84, 0x3f80
    s_mov_b32 s42, 65536
    s_mov_b32 s43, 0x20000
    s_cmp_ge_u32 s22, 5
    s_cbranch_scc1 A_N1
    s_cmp_lt_u32 s49, 250
    s_cselect_b32 s3, s49, 0
    s_cselect_b64 s[50:51], -1, 0
    s_mul_i32 s3, s3, 5120
    v_lshl_add_u32 v8, v0, 4, s3
    v_lshlrev_b32 v9, 1, v8
    s_lshl_b32 s44, s22, 3
    v_add_u32 v1, s44, v126
    v_xor_b32 v2, v1, v127
    v_and_b32 v2, 15, v2
    v_lshlrev_b32 v2, 4, v2
    v_lshl_add_u32 v2, v1, 8, v2
    v_xor_b32 v3, 64, v2
    s_lshl_b32 s44, s22, 11
    s_add_u32 m0, s44, 5376
    s_lshl_b32 s46, s23, 8
    s_mov_b32 s26, 2560000
    s_mov_b32 s27, 0x20000
    s_waitcnt lgkmcnt(0)
    global_load_dwordx4 v[12:15], v8, s[10:11]
    s_mov_b32 s24, s4
    s_and_b32 s25, s5, 0xffff
    buffer_load_dwordx4 v2, s[24:27], s46 offen  lds
    buffer_load_dwordx4 v3, s[24:27], s46 offen offset:1024  lds
    s_barrier
    global_load_dwordx4 v[16:19], v8, s[8:9]
    global_load_dwordx4 v[20:23], v9, s[6:7]
    global_load_dwordx4 v[24:27], v9, s[6:7] offset:16
    s_movk_i32 s44, 625
    s_mov_b32 s45, 214749
    v_mov_b32 v1, 1
    v_lshlrev_b32 v10, 4, v97
    s_waitcnt vmcnt(5)
    s_mov_b64 exec, s[50:51]
    v_mul_u32_u24 v28, s45, v12
    v_mul_u32_u24 v29, s45, v13
    v_mul_u32_u24 v30, s45, v14
    v_mul_u32_u24 v31, s45, v15
    v_lshrrev_b32 v28, 23, v28
    v_lshlrev_b32 v32, 2, v28
    ds_add_rtn_u32 v36, v32, v1 offset:36608
    v_lshrrev_b32 v29, 23, v29
    v_lshlrev_b32 v33, 2, v29
    ds_add_rtn_u32 v37, v33, v1 offset:36608
    v_lshrrev_b32 v30, 23, v30
    v_lshlrev_b32 v34, 2, v30
    ds_add_rtn_u32 v38, v34, v1 offset:36608
    v_lshrrev_b32 v31, 23, v31
    v_lshlrev_b32 v35, 2, v31
    ds_add_rtn_u32 v39, v35, v1 offset:36608
    s_mov_b64 exec, -1
    s_waitcnt lgkmcnt(0)
    s_barrier
    ds_read_b128 v[40:43], v10 offset:36608
    v_mad_u32_u24 v28, v28, s44, 15
    v_lshrrev_b32 v28, 4, v28
    v_sub_u32 v28, v12, v28
    v_mad_u32_u24 v29, v29, s44, 15
    v_lshrrev_b32 v29, 4, v29
    v_sub_u32 v29, v13, v29
    v_mad_u32_u24 v30, v30, s44, 15
    v_lshrrev_b32 v30, 4, v30
    v_sub_u32 v30, v14, v30
    v_mad_u32_u24 v31, v31, s44, 15
    v_lshrrev_b32 v31, 4, v31
    v_sub_u32 v31, v15, v31
    s_waitcnt vmcnt(3)
    s_barrier
    s_waitcnt lgkmcnt(0)
    v_add_u32 v44, v40, v41
    v_add3_u32 v44, v44, v42, v43
    v_mov_b32 v45, v44
    s_nop 1
    v_add_u32_dpp v45, v45, v45 row_shr:1 row_mask:0xf bank_mask:0xf bound_ctrl:0
    s_nop 1
    v_add_u32_dpp v45, v45, v45 row_shr:2 row_mask:0xf bank_mask:0xf bound_ctrl:0
    s_nop 1
    v_add_u32_dpp v45, v45, v45 row_shr:4 row_mask:0xf bank_mask:0xf bound_ctrl:0
    s_nop 1
    v_add_u32_dpp v45, v45, v45 row_shr:8 row_mask:0xf bank_mask:0xf bound_ctrl:0
    s_nop 1
    v_add_u32_dpp v45, v45, v45 row_bcast:15 row_mask:0xa bank_mask:0xf
    s_nop 1
    v_add_u32_dpp v45, v45, v45 row_bcast:31 row_mask:0xc bank_mask:0xf
    v_sub_u32 v48, v45, v44
    v_add_u32 v49, v48, v40
    v_add_u32 v50, v49, v41
    v_add_u32 v51, v50, v42
    ds_write_b128 v10, v[48:51] offset:37632
    s_mov_b32 s44, 16128
    s_mov_b64 exec, s[50:51]
    s_waitcnt lgkmcnt(0)
    ds_read_b32 v40, v32 offset:37632
    ds_read_b32 v41, v33 offset:37632
    ds_read_b32 v42, v34 offset:37632
    ds_read_b32 v43, v35 offset:37632
    s_waitcnt lgkmcnt(0)
    v_add_u32 v40, v40, v36
    v_mad_u32_u24 v40, v40, 12, s44
    v_add_u32 v41, v41, v37
    v_mad_u32_u24 v41, v41, 12, s44
    v_add_u32 v42, v42, v38
    v_mad_u32_u24 v42, v42, 12, s44
    v_add_u32 v43, v43, v39
    v_mad_u32_u24 v43, v43, 12, s44
    s_waitcnt vmcnt(2)
    v_lshl_or_b32 v16, v28, 18, v16
    ds_write_b32 v40, v16 offset:8
    v_lshl_or_b32 v17, v29, 18, v17
    ds_write_b32 v41, v17 offset:8
    v_lshl_or_b32 v18, v30, 18, v18
    ds_write_b32 v42, v18 offset:8
    v_lshl_or_b32 v19, v31, 18, v19
    ds_write_b32 v43, v19 offset:8
    s_waitcnt vmcnt(1)
    ds_write2_b32 v40, v20, v21 offset0:0 offset1:1
    ds_write2_b32 v41, v22, v23 offset0:0 offset1:1
    s_waitcnt vmcnt(0)
    ds_write2_b32 v42, v24, v25 offset0:0 offset1:1
    ds_write2_b32 v43, v26, v27 offset0:0 offset1:1
    s_mov_b64 exec, -1
    s_branch A_JOINC
A_N1:
    v_mov_b32 v8, 0
    v_lshlrev_b32 v6, 1, v126
    v_xor_b32 v6, v6, v127
    v_lshlrev_b32 v6, 4, v6
    v_lshl_add_u32 v6, v126, 8, v6
    v_xor_b32 v7, 128, v6
    s_sub_u32 s71, s22, 5
    s_lshl_b32 s71, s71, 12
    s_add_u32 m0, s71, 93952
    s_waitcnt lgkmcnt(0)
    s_mov_b32 s40, s12
    s_and_b32 s41, s13, 0xffff
    s_cmp_ge_u32 s22, 13
    s_cbranch_scc1 A_N13
    buffer_load_dwordx4 v6, s[40:43], s71 offen lds
    buffer_load_dwordx4 v6, s[40:43], s71 offen offset:1024 lds
    buffer_load_dwordx4 v7, s[40:43], s71 offen offset:2048 lds
    buffer_load_dwordx4 v7, s[40:43], s71 offen offset:3072 lds
    s_cmp_ge_u32 s22, 10
    s_cbranch_scc1 A_N10
    s_mov_b32 s45, 35328
    s_cmp_eq_u32 s22, 9
    s_cselect_b32 s45, -2304, s45
    v_lshl_add_u32 v3, v0, 2, s45
    ds_write_b32 v3, v8
    ds_write_b32 v8, v8 offset:256
    ds_write_b32 v8, v8 offset:260
    s_cbranch_scc0 A_B0
    ds_write_b32 v3, v8 offset:512
    s_branch A_B0
A_N13:
    s_cmp_eq_u32 s22, 15
    s_cbranch_scc1 A_N15
    s_and_b32 s44, s49, 31
    s_lshl_b32 s44, s44, 10
    s_cmp_eq_u32 s22, 13
    s_cselect_b32 s45, 32768, 0
    s_cselect_b32 s46, s12, s14
    s_cselect_b32 s47, s13, s15
    s_add_u32 s44, s44, s45
    v_lshl_add_u32 v3, v97, 7, s44
    s_mov_b64 exec, 0xff
    global_load_dword v40, v3, s[46:47]
    s_mov_b64 exec, -1
    s_cmp_eq_u32 s22, 14
    s_cbranch_scc0 A_N10
    s_branch A_B0
A_N10:
    v_lshlrev_b32 v3, 4, v0
    v_add_u32 v3, -9216, v3
    v_mov_b64 v[12:13], -1
    v_mov_b64 v[14:15], -1
    ds_write_b128 v3, v[12:15]
    s_branch A_B0
A_N15:
    s_cmp_lg_u32 s2, 0
    s_cbranch_scc1 A_B0
    s_memrealtime s[60:61]
    s_waitcnt lgkmcnt(0)
    s_or_b32 s60, s60, 1
    v_mov_b32 v10, s60
    v_mov_b32 v11, s61
    s_mov_b64 exec, 1
    global_store_dwordx2 v8, v[10:11], s[18:19] sc1
    s_mov_b64 exec, -1
A_B0:
    s_cmp_eq_u32 s22, 15
    s_cbranch_scc1 A_B1
    v_lshlrev_b32 v3, 4, v0
    v_add_u32 v3, 47872, v3
    v_mov_b64 v[12:13], 0
    v_mov_b64 v[14:15], 0
    ds_write_b128 v3, v[12:15]
    ds_write_b128 v3, v[12:15] offset:10240
    ds_write_b128 v3, v[12:15] offset:20480
    ds_write_b128 v3, v[12:15] offset:30720
A_B1:
    s_waitcnt lgkmcnt(4)
    s_barrier
    s_cmp_eq_u32 s22, 15
    s_cbranch_scc0 A_NO15
    v_bfe_u32 v9, v97, 4, 1
    v_lshlrev_b32 v9, 6, v9
    v_lshrrev_b32 v10, 5, v97
    v_lshl_add_u32 v9, v10, 5, v9
    v_add_u32 v9, v9, v127
    v_lshlrev_b32 v9, 1, v9
    v_add_u32 v8, 65536, v9
    global_load_ushort v16, v8, s[12:13] offset:0
    global_load_ushort v17, v8, s[12:13] offset:256
    global_load_ushort v18, v8, s[12:13] offset:512
    global_load_ushort v19, v8, s[12:13] offset:768
    global_load_ushort v20, v8, s[12:13] offset:32
    global_load_ushort v21, v8, s[12:13] offset:288
    global_load_ushort v22, v8, s[12:13] offset:544
    global_load_ushort v23, v8, s[12:13] offset:800
    s_cmp_ge_u32 s49, 32
    s_cbranch_scc1 A_NO15
    s_and_b32 s44, s49, 1
    s_lshl_b32 s44, s44, 6
    s_bfe_u32 s45, s49, 0x10001
    s_lshl_b32 s45, s45, 5
    s_add_u32 s44, s44, s45
    s_add_u32 s44, s44, 128
    s_lshl_b32 s44, s44, 8
    s_bfe_u32 s45, s49, 0x30002
    s_lshl_b32 s45, s45, 5
    s_add_u32 s44, s44, s45
    v_lshlrev_b32 v8, 10, v126
    v_lshl_add_u32 v8, v127, 1, v8
    v_add_u32 v8, s44, v8
    v_add_u32 v9, 4096, v8
    global_load_ushort v24, v8, s[14:15] offset:0
    global_load_ushort v25, v9, s[14:15] offset:0
    global_load_ushort v26, v8, s[14:15] offset:256
    global_load_ushort v27, v9, s[14:15] offset:256
    global_load_ushort v28, v8, s[14:15] offset:512
    global_load_ushort v29, v9, s[14:15] offset:512
    global_load_ushort v30, v8, s[14:15] offset:768
    global_load_ushort v31, v9, s[14:15] offset:768
A_NO15:
    v_lshlrev_b32 v106, 3, v97
    v_lshlrev_b32 v82, 2, v97
    v_lshlrev_b32 v101, 4, v127
    v_lshlrev_b32 v103, 4, v127
    v_lshlrev_b32 v81, 1, v126
    v_lshrrev_b32 v1, 5, v97
    v_bfe_u32 v2, v97, 2, 1
    v_and_b32 v3, 1, v97
    v_bfe_u32 v4, v97, 1, 1
    v_bfe_u32 v5, v97, 3, 2
    v_lshl_add_u32 v5, v5, 1, v4
    v_mov_b64 v[72:73], 0
    v_mov_b64 v[74:75], 0
    v_xor_b32 v76, v1, v2
    v_lshl_add_u32 v76, v76, 1, v3
    v_cmp_eq_u32 s[34:35], 0, v76
    v_cmp_eq_u32 s[36:37], 1, v76
    v_lshlrev_b32 v111, 3, v5
    v_lshrrev_b32 v77, 2, v5
    v_cmp_eq_u32 vcc, v1, v77
    v_bfe_u32 v5, v5, 1, 1
    v_lshl_add_u32 v5, v4, 1, v5
    v_lshl_add_u32 v2, v2, 1, v3
    v_cndmask_b32 v3, 0, v84, vcc
    v_lshlrev_b32 v4, 2, v5
    v_lshlrev_b32 v80, v4, v2
    v_cmp_eq_u32 s[52:53], 0, v5
    v_cmp_eq_u32 s[54:55], 1, v5
    v_cmp_eq_u32 s[56:57], 2, v5
    v_cmp_eq_u32 s[58:59], 3, v5
    v_lshrrev_b32 v1, 2, v108
    v_and_b32 v2, 3, v108
    v_cndmask_b32 v76, 0, v3, s[52:53]
    v_cndmask_b32 v77, 0, v3, s[54:55]
    v_cndmask_b32 v78, 0, v3, s[56:57]
    v_cndmask_b32 v79, 0, v3, s[58:59]
    s_movk_i32 s3, 15488
    v_mul_u32_u24 v3, s3, v1
    v_mad_u32_u24 v110, v2, 12, v3
    s_lshl_b32 s3, s49, 3
    s_add_u32 s3, s3, 6619136
    v_lshl_add_u32 v105, v1, 11, s3
    v_xor_b32 v1, v126, v127
    v_lshlrev_b32 v1, 4, v1
    v_lshl_add_u32 v120, v127, 8, v1
    v_xor_b32 v121, 64, v120
    v_xor_b32 v122, 128, v120
    v_xor_b32 v123, 192, v120
    v_bfe_u32 v1, v97, 2, 2
    v_and_b32 v2, 1, v126
    v_lshl_or_b32 v2, v2, 2, v1
    v_bfe_u32 v3, v97, 1, 1
    v_lshl_or_b32 v2, v2, 1, v3
    v_and_b32 v3, 1, v97
    v_lshl_or_b32 v2, v2, 1, v3
    v_lshl_add_u32 v1, v126, 3, v1
    v_lshlrev_b32 v1, 8, v1
    v_lshl_add_u32 v92, v2, 3, v1
    s_and_b32 s3, s22, 7
    s_lshl_b32 s3, s3, 1
    v_lshrrev_b32 v1, 1, v126
    v_or_b32 v1, s3, v1
    v_xor_b32 v1, v1, v127
    v_and_b32 v2, 1, v126
    v_lshl_or_b32 v1, v1, 1, v2
    v_lshlrev_b32 v1, 3, v1
    v_lshl_add_u32 v124, v127, 8, v1
    v_lshrrev_b32 v1, 4, v108
    v_xor_b32 v2, v1, v127
    v_and_b32 v2, 15, v2
    v_lshlrev_b32 v2, 4, v2
    v_lshl_add_u32 v125, v1, 8, v2
    s_lshl_b32 s3, s23, 8
    v_lshl_add_u32 v83, v108, 4, s3
    s_barrier
    s_cmp_ge_u32 s22, 11
    s_cbranch_scc1 A_G11
    s_sub_u32 s3, s22, 5
    s_and_b32 s45, s3, 1
    s_lshr_b32 s44, s3, 1
    s_lshl_b32 s46, s44, 12
    v_add_u32 v0, s46, v120
    v_add_u32 v1, s46, v121
    v_add_u32 v2, s46, v122
    v_add_u32 v3, s46, v123
    s_lshl_b32 s45, s45, 7
    v_xor_b32 v4, s45, v92
    v_add_u32 v4, 93952, v4
    v_xor_b32 v5, 32, v4
    v_xor_b32 v6, 64, v4
    v_xor_b32 v7, 96, v4
    s_add_u32 s46, s46, s45
    s_lshl_b32 s45, s23, 8
    s_add_u32 s46, s46, s45
    s_add_u32 s46, s46, 4096
    v_lshlrev_b32 v94, 10, v126
    v_lshl_add_u32 v94, v127, 3, v94
    v_add_u32 v94, s46, v94
    s_mov_b32 s46, 0xbfb8aa3b
    s_waitcnt vmcnt(0)
    s_barrier
    s_setprio 1
    ds_read_b128 v[40:43], v0 offset:5376
    ds_read_b64_tr_b16 v[8:9], v4 offset:0
    ds_read_b64_tr_b16 v[10:11], v4 offset:1024
    ds_read_b64_tr_b16 v[12:13], v5 offset:0
    ds_read_b64_tr_b16 v[14:15], v5 offset:1024
    ds_read_b64_tr_b16 v[16:17], v6 offset:0
    ds_read_b64_tr_b16 v[18:19], v6 offset:1024
    ds_read_b64_tr_b16 v[20:21], v7 offset:0
    ds_read_b64_tr_b16 v[22:23], v7 offset:1024
    ds_read_b128 v[44:47], v1 offset:5376
    ds_read_b64_tr_b16 v[24:25], v4 offset:8192
    ds_read_b64_tr_b16 v[26:27], v4 offset:9216
    ds_read_b64_tr_b16 v[28:29], v5 offset:8192
    ds_read_b64_tr_b16 v[30:31], v5 offset:9216
    ds_read_b64_tr_b16 v[32:33], v6 offset:8192
    ds_read_b64_tr_b16 v[34:35], v6 offset:9216
    ds_read_b64_tr_b16 v[36:37], v7 offset:8192
    ds_read_b64_tr_b16 v[38:39], v7 offset:9216
    s_waitcnt lgkmcnt(9)
    v_mfma_f32_16x16x32_bf16 v[56:59], v[40:43], v[8:11], 0
    v_mfma_f32_16x16x32_bf16 v[60:63], v[40:43], v[12:15], 0
    v_mfma_f32_16x16x32_bf16 v[64:67], v[40:43], v[16:19], 0
    v_mfma_f32_16x16x32_bf16 v[68:71], v[40:43], v[20:23], 0
    ds_read_b128 v[48:51], v2 offset:5376
    ds_read_b64_tr_b16 v[8:9], v4 offset:16384
    ds_read_b64_tr_b16 v[10:11], v4 offset:17408
    ds_read_b64_tr_b16 v[12:13], v5 offset:16384
    ds_read_b64_tr_b16 v[14:15], v5 offset:17408
    ds_read_b64_tr_b16 v[16:17], v6 offset:16384
    ds_read_b64_tr_b16 v[18:19], v6 offset:17408
    ds_read_b64_tr_b16 v[20:21], v7 offset:16384
    ds_read_b64_tr_b16 v[22:23], v7 offset:17408
    s_waitcnt lgkmcnt(9)
    v_mfma_f32_16x16x32_bf16 v[56:59], v[44:47], v[24:27], v[56:59]
    v_mfma_f32_16x16x32_bf16 v[60:63], v[44:47], v[28:31], v[60:63]
    v_mfma_f32_16x16x32_bf16 v[64:67], v[44:47], v[32:35], v[64:67]
    v_mfma_f32_16x16x32_bf16 v[68:71], v[44:47], v[36:39], v[68:71]
    ds_read_b128 v[52:55], v3 offset:5376
    ds_read_b64_tr_b16 v[24:25], v4 offset:24576
    ds_read_b64_tr_b16 v[26:27], v4 offset:25600
    ds_read_b64_tr_b16 v[28:29], v5 offset:24576
    ds_read_b64_tr_b16 v[30:31], v5 offset:25600
    ds_read_b64_tr_b16 v[32:33], v6 offset:24576
    ds_read_b64_tr_b16 v[34:35], v6 offset:25600
    ds_read_b64_tr_b16 v[36:37], v7 offset:24576
    ds_read_b64_tr_b16 v[38:39], v7 offset:25600
    s_waitcnt lgkmcnt(9)
    v_mfma_f32_16x16x32_bf16 v[56:59], v[48:51], v[8:11], v[56:59]
    v_mfma_f32_16x16x32_bf16 v[60:63], v[48:51], v[12:15], v[60:63]
    v_mfma_f32_16x16x32_bf16 v[64:67], v[48:51], v[16:19], v[64:67]
    v_mfma_f32_16x16x32_bf16 v[68:71], v[48:51], v[20:23], v[68:71]
    s_waitcnt lgkmcnt(0)
    v_mfma_f32_16x16x32_bf16 v[56:59], v[52:55], v[24:27], v[56:59]
    v_mfma_f32_16x16x32_bf16 v[60:63], v[52:55], v[28:31], v[60:63]
    v_mfma_f32_16x16x32_bf16 v[64:67], v[52:55], v[32:35], v[64:67]
    v_mfma_f32_16x16x32_bf16 v[68:71], v[52:55], v[36:39], v[68:71]
    s_cmp_eq_u32 s44, 2
    s_cselect_b32 exec_hi, 0, -1
    s_nop 5
    v_pk_mul_f32 v[56:57], v[56:57], s[46:47] op_sel_hi:[1,0]
    v_pk_mul_f32 v[58:59], v[58:59], s[46:47] op_sel_hi:[1,0]
    v_pk_mul_f32 v[60:61], v[60:61], s[46:47] op_sel_hi:[1,0]
    v_pk_mul_f32 v[62:63], v[62:63], s[46:47] op_sel_hi:[1,0]
    v_pk_mul_f32 v[64:65], v[64:65], s[46:47] op_sel_hi:[1,0]
    v_pk_mul_f32 v[66:67], v[66:67], s[46:47] op_sel_hi:[1,0]
    v_pk_mul_f32 v[68:69], v[68:69], s[46:47] op_sel_hi:[1,0]
    v_pk_mul_f32 v[70:71], v[70:71], s[46:47] op_sel_hi:[1,0]
    v_cvt_pk_bf16_f32 v8, v56, v60
    v_cvt_pk_bf16_f32 v9, v64, v68
    global_store_dwordx2 v94, v[8:9], s[20:21] offset:0 sc1
    v_cvt_pk_bf16_f32 v10, v57, v61
    v_cvt_pk_bf16_f32 v11, v65, v69
    global_store_dwordx2 v94, v[10:11], s[20:21] offset:256 sc1
    v_cvt_pk_bf16_f32 v12, v58, v62
    v_cvt_pk_bf16_f32 v13, v66, v70
    global_store_dwordx2 v94, v[12:13], s[20:21] offset:512 sc1
    v_cvt_pk_bf16_f32 v14, v59, v63
    v_cvt_pk_bf16_f32 v15, v67, v71
    global_store_dwordx2 v94, v[14:15], s[20:21] offset:768 sc1
    s_mov_b64 exec, -1
    s_setprio 0
    s_branch A_JOIN
A_G11:
    s_cmp_eq_u32 s22, 15
    s_cbranch_scc1 A_G15
    s_waitcnt vmcnt(0)
    s_barrier
    s_branch A_JOIN
A_G15:
    s_barrier
    v_mov_b32 v8, 0
    s_mov_b32 s63, 400000
A_NLOOP:
    global_load_dwordx2 v[10:11], v8, s[18:19] sc1
    s_sub_u32 s63, s63, 1
    s_cbranch_scc1 A_NDONE
    s_waitcnt vmcnt(0)
    v_cmp_eq_u32 vcc, 0, v10
    s_cbranch_vccnz A_NLOOP
A_NDONE:
    s_waitcnt vmcnt(0)
    v_lshrrev_b32 v12, 4, v10
    v_xor_b32 v11, v11, v12
    v_lshlrev_b32 v11, 22, v11
    ds_write_b64 v8, v[10:11] offset:272
    s_mov_b32 s44, 0xbfb8aa3b
    v_lshlrev_b32 v16, 16, v16
    v_mul_f32 v16, s44, v16
    v_lshlrev_b32 v17, 16, v17
    v_mul_f32 v17, s44, v17
    v_lshlrev_b32 v18, 16, v18
    v_mul_f32 v18, s44, v18
    v_lshlrev_b32 v19, 16, v19
    v_mul_f32 v19, s44, v19
    v_lshlrev_b32 v20, 16, v20
    v_mul_f32 v20, s44, v20
    v_lshlrev_b32 v21, 16, v21
    v_mul_f32 v21, s44, v21
    v_lshlrev_b32 v22, 16, v22
    v_mul_f32 v22, s44, v22
    v_lshlrev_b32 v23, 16, v23
    v_mul_f32 v23, s44, v23
    v_cvt_pk_bf16_f32 v12, v16, v17
    v_cvt_pk_bf16_f32 v13, v18, v19
    v_cvt_pk_bf16_f32 v14, v20, v21
    v_cvt_pk_bf16_f32 v15, v22, v23
    v_lshlrev_b32 v8, 4, v97
    ds_write_b128 v8, v[12:15] offset:38656
    s_cmp_ge_u32 s49, 32
    s_cbranch_scc1 A_JOIN
    v_lshl_or_b32 v32, v25, 16, v24
    v_lshl_or_b32 v33, v27, 16, v26
    v_lshl_or_b32 v34, v29, 16, v28
    v_lshl_or_b32 v35, v31, 16, v30
    s_lshl_b32 s44, s49, 10
    s_add_u32 s44, s44, 7143424
    v_add_u32 v8, s44, v8
    global_store_dwordx4 v8, v[32:35], s[20:21] sc1
A_JOIN:
    s_cmp_lt_u32 s22, 8
    s_cbranch_scc1 A_JOINB
    v_lshlrev_b32 v0, 4, v108
    s_mul_i32 s44, s49, 15488
    s_add_u32 s44, s44, 2621440
    v_add_u32 v1, s44, v0
    v_mov_b32 v3, 0
    s_waitcnt lgkmcnt(0)
    s_barrier
    s_cmp_eq_u32 s22, 15
    s_cbranch_scc1 A_C15
    ds_read_b128 v[4:7], v0 offset:16128
    ds_read_b64 v[98:99], v3 offset:272
    s_branch A_C8
A_JOINB:
    v_lshlrev_b32 v0, 4, v108
    s_mul_i32 s44, s49, 15488
    s_add_u32 s44, s44, 2621440
    v_add_u32 v1, s44, v0
    v_mov_b32 v3, 0
    s_lshl_b32 s71, s22, 12
    s_add_u32 m0, s71, 126720
    s_add_u32 s71, s71, 32768
    s_mov_b32 s40, s12
    s_and_b32 s41, s13, 0xffff
    s_waitcnt lgkmcnt(0)
    s_barrier
    ds_read_b128 v[4:7], v0 offset:16128
    ds_read_b64 v[98:99], v3 offset:272
    s_waitcnt lgkmcnt(1)
    global_store_dwordx4 v1, v[4:7], s[20:21] sc1
    v_lshlrev_b32 v14, 1, v126
    v_xor_b32 v14, v14, v127
    v_lshlrev_b32 v14, 4, v14
    v_lshl_add_u32 v14, v126, 8, v14
    v_xor_b32 v15, 128, v14
    s_barrier
    buffer_load_dwordx4 v14, s[40:43], s71 offen lds
    buffer_load_dwordx4 v14, s[40:43], s71 offen offset:1024 lds
    buffer_load_dwordx4 v15, s[40:43], s71 offen offset:2048 lds
    buffer_load_dwordx4 v15, s[40:43], s71 offen offset:3072 lds
    s_waitcnt vmcnt(4)
    s_barrier
    s_barrier
    s_branch A_DESC
A_JOINC:
    v_lshlrev_b32 v0, 4, v108
    s_mul_i32 s44, s49, 15488
    s_add_u32 s44, s44, 2621440
    v_add_u32 v1, s44, v0
    v_mov_b32 v3, 0
    s_lshl_b32 s71, s22, 12
    s_add_u32 m0, s71, 126720
    s_add_u32 s71, s71, 32768
    s_mov_b32 s40, s12
    s_and_b32 s41, s13, 0xffff
    s_waitcnt lgkmcnt(0)
    s_barrier
    ds_read_b128 v[4:7], v0 offset:16128
    ds_read_b64 v[98:99], v3 offset:272
    s_waitcnt lgkmcnt(1)
    global_store_dwordx4 v1, v[4:7], s[20:21] sc1
    v_lshlrev_b32 v14, 1, v126
    v_xor_b32 v14, v14, v127
    v_lshlrev_b32 v14, 4, v14
    v_lshl_add_u32 v14, v126, 8, v14
    v_xor_b32 v15, 128, v14
    s_barrier
    buffer_load_dwordx4 v14, s[40:43], s71 offen lds
    buffer_load_dwordx4 v14, s[40:43], s71 offen offset:1024 lds
    buffer_load_dwordx4 v15, s[40:43], s71 offen offset:2048 lds
    buffer_load_dwordx4 v15, s[40:43], s71 offen offset:3072 lds
    v_lshlrev_b32 v106, 3, v97
    v_lshlrev_b32 v82, 2, v97
    v_lshlrev_b32 v101, 4, v127
    v_lshlrev_b32 v103, 4, v127
    v_lshlrev_b32 v81, 1, v126
    v_lshrrev_b32 v1, 5, v97
    v_bfe_u32 v2, v97, 2, 1
    v_and_b32 v3, 1, v97
    v_bfe_u32 v4, v97, 1, 1
    v_bfe_u32 v5, v97, 3, 2
    v_lshl_add_u32 v5, v5, 1, v4
    v_mov_b64 v[72:73], 0
    v_mov_b64 v[74:75], 0
    v_xor_b32 v76, v1, v2
    v_lshl_add_u32 v76, v76, 1, v3
    v_cmp_eq_u32 s[34:35], 0, v76
    v_cmp_eq_u32 s[36:37], 1, v76
    v_lshlrev_b32 v111, 3, v5
    v_lshrrev_b32 v77, 2, v5
    v_cmp_eq_u32 vcc, v1, v77
    v_bfe_u32 v5, v5, 1, 1
    v_lshl_add_u32 v5, v4, 1, v5
    v_lshl_add_u32 v2, v2, 1, v3
    v_cndmask_b32 v3, 0, v84, vcc
    v_lshlrev_b32 v4, 2, v5
    v_lshlrev_b32 v80, v4, v2
    v_cmp_eq_u32 s[52:53], 0, v5
    v_cmp_eq_u32 s[54:55], 1, v5
    v_cmp_eq_u32 s[56:57], 2, v5
    v_cmp_eq_u32 s[58:59], 3, v5
    v_lshrrev_b32 v1, 2, v108
    v_and_b32 v2, 3, v108
    v_cndmask_b32 v76, 0, v3, s[52:53]
    v_cndmask_b32 v77, 0, v3, s[54:55]
    v_cndmask_b32 v78, 0, v3, s[56:57]
    v_cndmask_b32 v79, 0, v3, s[58:59]
    s_movk_i32 s3, 15488
    v_mul_u32_u24 v3, s3, v1
    v_mad_u32_u24 v110, v2, 12, v3
    s_lshl_b32 s3, s49, 3
    s_add_u32 s3, s3, 6619136
    v_lshl_add_u32 v105, v1, 11, s3
    v_xor_b32 v1, v126, v127
    v_lshlrev_b32 v1, 4, v1
    v_lshl_add_u32 v120, v127, 8, v1
    v_xor_b32 v121, 64, v120
    v_xor_b32 v122, 128, v120
    v_xor_b32 v123, 192, v120
    v_bfe_u32 v1, v97, 2, 2
    v_and_b32 v2, 1, v126
    v_lshl_or_b32 v2, v2, 2, v1
    v_bfe_u32 v3, v97, 1, 1
    v_lshl_or_b32 v2, v2, 1, v3
    v_and_b32 v3, 1, v97
    v_lshl_or_b32 v2, v2, 1, v3
    v_lshl_add_u32 v1, v126, 3, v1
    v_lshlrev_b32 v1, 8, v1
    v_lshl_add_u32 v92, v2, 3, v1
    s_and_b32 s3, s22, 7
    s_lshl_b32 s3, s3, 1
    v_lshrrev_b32 v1, 1, v126
    v_or_b32 v1, s3, v1
    v_xor_b32 v1, v1, v127
    v_and_b32 v2, 1, v126
    v_lshl_or_b32 v1, v1, 1, v2
    v_lshlrev_b32 v1, 3, v1
    v_lshl_add_u32 v124, v127, 8, v1
    v_lshrrev_b32 v1, 4, v108
    v_xor_b32 v2, v1, v127
    v_and_b32 v2, 15, v2
    v_lshlrev_b32 v2, 4, v2
    v_lshl_add_u32 v125, v1, 8, v2
    s_lshl_b32 s3, s23, 8
    v_lshl_add_u32 v83, v108, 4, s3
    s_waitcnt vmcnt(4)
    s_barrier
    s_barrier
    s_branch A_DESC
A_C15:
    ds_read_b64 v[98:99], v3 offset:272
    s_branch A_C9
A_C8:
    s_waitcnt lgkmcnt(1)
    global_store_dwordx4 v1, v[4:7], s[20:21] sc1
A_C9:
    s_barrier
    s_cmp_lt_u32 s22, 14
    s_cbranch_scc1 A_NOT
    s_setprio 1
    v_lshlrev_b32 v8, 3, v108
    ds_read_b64 v[10:11], v8 offset:30464
    ds_read_b64 v[12:13], v8 offset:29440
    s_lshl_b32 s44, s49, 11
    s_add_u32 s44, s44, 6604800
    v_lshl_add_u32 v8, v8, 1, s44
    s_waitcnt lgkmcnt(0)
    v_lshl_or_b32 v4, v12, 11, v10
    v_lshl_or_b32 v6, v13, 11, v11
    v_or_b32 v4, v99, v4
    v_or_b32 v6, v99, v6
    v_mov_b32 v5, v98
    v_mov_b32 v7, v98
A_NOT:
    s_lshl_b32 s71, s22, 12
    s_sub_u32 s71, s71, 32768
    s_add_u32 m0, s71, 93952
    s_mov_b32 s40, s14
    s_and_b32 s41, s15, 0xffff
    v_lshlrev_b32 v14, 1, v126
    v_xor_b32 v14, v14, v127
    v_lshlrev_b32 v14, 4, v14
    v_lshl_add_u32 v14, v126, 8, v14
    v_xor_b32 v15, 128, v14
    s_cmp_lt_u32 s22, 14
    s_waitcnt vmcnt(0)
    s_barrier
    s_cbranch_scc1 A_PUB
    global_store_dwordx4 v8, v[4:7], s[20:21] sc1
    s_setprio 0
A_PUB:
    s_barrier
    buffer_load_dwordx4 v14, s[40:43], s71 offen lds
    buffer_load_dwordx4 v14, s[40:43], s71 offen offset:1024 lds
    buffer_load_dwordx4 v15, s[40:43], s71 offen offset:2048 lds
    buffer_load_dwordx4 v15, s[40:43], s71 offen offset:3072 lds
A_DESC:
    v_lshlrev_b32 v3, 4, v97
    ds_read_b128 v[84:87], v3 offset:38656
    s_mov_b32 s28, s16
    s_and_b32 s29, s17, 0xffff
    s_lshl_b32 s30, s62, 8
    s_mov_b32 s31, 0x20000
    s_add_u32 s24, s20, 4096
    s_addc_u32 s25, s21, 0
    s_and_b32 s25, s25, 0xffff
    s_or_b32 s25, s25, 16777216
    s_mov_b32 s26, 10000
    s_mov_b32 s27, 0x20000
    s_sub_u32 s64, s24, 1024
    s_subb_u32 s65, s25, 0
    s_mov_b32 s66, 10000
    s_mov_b32 s67, 0x20000
    s_add_u32 s4, s20, 2621440
    s_addc_u32 s5, s21, 0
    s_and_b32 s5, s5, 0xffff
    s_mov_b32 s6, 3964928
    s_mov_b32 s7, 0x20000
    s_mov_b32 s9, 0
    s_mov_b32 s8, 0
    s_mov_b32 s17, 20
    s_mov_b32 s38, 1.0
    s_mov_b32 s39, 1.0
    s_mov_b32 s63, 400000
    v_mov_b64 v[94:95], 0
    v_mov_b32 v96, 0
    s_and_b32 s44, s22, 7
    s_lshl_b32 s44, s44, 5
    v_xor_b32 v92, s44, v92
    s_and_b32 s44, s22, 8
    s_lshl_b32 s44, s44, 12
    s_add_u32 s44, s44, 93952
    v_add_u32 v92, s44, v92
    s_bfe_u32 s44, s22, 0x10002
    s_lshl_b32 s44, s44, 7
    s_bfe_u32 s45, s22, 0x10001
    s_lshl_b32 s45, s45, 8
    s_add_u32 s44, s44, s45
    s_and_b32 s45, s22, 1
    s_lshl_b32 s45, s45, 2
    s_add_u32 s44, s44, s45
    v_lshlrev_b32 v104, 11, v126
    v_lshl_add_u32 v104, v127, 3, v104
    v_add_u32 v104, s44, v104
    s_waitcnt lgkmcnt(1)
    v_readfirstlane_b32 s60, v98
    v_readfirstlane_b32 s61, v99
A_QD:
    s_lshl_b32 s40, s22, 12
    s_add_u32 s40, s40, 93952
    s_add_u32 s41, s40, 2048
    s_and_b32 s42, s22, 3
    s_lshl_b32 s42, s42, 2
    s_lshr_b32 s44, s22, 2
    s_or_b32 s42, s42, s44
    v_add_u32 v99, s40, v106
    s_mov_b32 s3, 1
    v_mov_b32 v19, 0x3fffff
    v_and_b32 v22, 3, v108
    s_waitcnt vmcnt(0) lgkmcnt(0)
    s_barrier
    s_cmp_lt_u32 s22, 8
    s_cbranch_scc1 A_P0
    s_setprio 1
A_P0:
T_LOOP:
    global_load_dwordx2 v[20:21], v105, s[20:21] sc1
    s_sub_u32 s63, s63, 1
    s_cbranch_scc1 T_DONE
    s_waitcnt vmcnt(0)
    v_xor_b32 v109, s61, v20
    v_cmp_ne_u32 vcc, s60, v21
    v_cmp_lt_u32 s[44:45], v19, v109
    s_or_b64 exec, vcc, s[44:45]
    s_cbranch_scc1 T_LOOP
T_DONE:
    s_mov_b64 exec, -1
    s_waitcnt vmcnt(0)
K_PASS:
    v_bfe_u32 v15, v109, 11, 11
    v_and_b32 v9, 0x7ff, v109
    v_subrev_u32 v15, s8, v15
    v_add_u32 v9, s8, v9
    v_cmp_gt_i32 s[50:51], v15, v22
    v_mad_u32_u24 v9, v9, 12, v110
    v_min_i32 v10, s17, v15
    v_sub_u32 v10, v10, v22
    s_mov_b64 exec, s[50:51]
    buffer_load_dwordx3 v[32:34], v9, s[4:7], 0 offen offset:0 sc1
    s_mov_b64 exec, -1
    v_cmp_lt_i32 s[52:53], 4, v10
    v_cmp_lt_i32 s[54:55], 8, v10
    v_cmp_lt_i32 s[56:57], 12, v10
    v_cmp_lt_i32 s[58:59], 16, v10
    v_cmp_lt_i32 vcc, s17, v15
    s_mov_b64 exec, s[52:53]
    buffer_load_dwordx3 v[36:38], v9, s[4:7], 0 offen offset:48 sc1
    s_mov_b64 exec, s[54:55]
    s_cbranch_execz K_LD
    buffer_load_dwordx3 v[40:42], v9, s[4:7], 0 offen offset:96 sc1
    s_mov_b64 exec, s[56:57]
    s_cbranch_execz K_LD
    buffer_load_dwordx3 v[44:46], v9, s[4:7], 0 offen offset:144 sc1
    s_mov_b64 exec, s[58:59]
    s_cbranch_execz K_LD
    buffer_load_dwordx3 v[48:50], v9, s[4:7], 0 offen offset:192 sc1
K_LD:
    s_mov_b64 exec, -1
    v_mov_b32 v13, 1
    v_lshrrev_b32 v14, 1, v106
    s_and_b32 s44, s22, 7
    s_lshl_b32 s44, s44, 12
    s_add_u32 s44, s44, 7143424
    s_add_u32 s60, s20, s44
    s_addc_u32 s61, s21, 0
    s_mov_b32 s63, 0x7b800000
    s_cbranch_vccz K_NOMORE
    v_mov_b32 v9, 0
    ds_write_b32 v9, v13 offset:256
K_NOMORE:
    s_and_b32 s44, s49, 31
    s_lshl_b32 s44, s44, 4
    s_add_u32 s44, s44, s22
    s_lshr_b32 s45, s49, 5
    s_lshl_b32 s45, s45, 6
    s_add_u32 s44, s44, s45
    s_and_b32 s44, s44, 511
    s_mul_i32 s44, s44, 1536
    s_add_u32 s44, s44, 1777664
    v_lshl_add_u32 v12, v106, 4, s44
    s_cmp_eq_u32 s3, 0
    s_mov_b32 s3, 0
    s_cbranch_scc1 K_NOU
    ds_read_b64_tr_b16 v[16:17], v92 offset:0
    ds_read_b64_tr_b16 v[18:19], v92 offset:1024
    ds_read_b64_tr_b16 v[20:21], v92 offset:8192
    ds_read_b64_tr_b16 v[22:23], v92 offset:9216
    ds_read_b64_tr_b16 v[24:25], v92 offset:16384
    ds_read_b64_tr_b16 v[26:27], v92 offset:17408
    ds_read_b64_tr_b16 v[28:29], v92 offset:24576
    ds_read_b64_tr_b16 v[30:31], v92 offset:25600
    ds_read_b128 v[52:55], v120 offset:5376
    ds_read_b128 v[56:59], v121 offset:5376
    ds_read_b128 v[60:63], v122 offset:5376
    ds_read_b128 v[64:67], v123 offset:5376
    s_mov_b32 s46, 0xbfb8aa3b
    s_cmp_ge_u32 s22, 8
    s_cbranch_scc1 K_Q
    ds_read_b128 v[0:3], v120 offset:13568
    ds_read_b128 v[4:7], v121 offset:13568
    ds_read_b128 v[8:11], v122 offset:13568
    ds_read_b128 v[68:71], v123 offset:13568
    s_waitcnt lgkmcnt(4)
    v_mfma_f32_16x16x32_bf16 v[112:115], v[16:19], v[52:55], 0
    v_mfma_f32_16x16x32_bf16 v[112:115], v[20:23], v[56:59], v[112:115]
    v_mfma_f32_16x16x32_bf16 v[112:115], v[24:27], v[60:63], v[112:115]
    v_mfma_f32_16x16x32_bf16 v[112:115], v[28:31], v[64:67], v[112:115]
    s_waitcnt lgkmcnt(0)
    v_mfma_f32_16x16x32_bf16 v[116:119], v[16:19], v[0:3], 0
    v_mfma_f32_16x16x32_bf16 v[116:119], v[20:23], v[4:7], v[116:119]
    v_mfma_f32_16x16x32_bf16 v[116:119], v[24:27], v[8:11], v[116:119]
    v_mfma_f32_16x16x32_bf16 v[116:119], v[28:31], v[68:71], v[116:119]
    s_nop 2
    v_pk_mul_f32 v[112:113], v[112:113], s[46:47] op_sel_hi:[1,0]
    v_pk_mul_f32 v[114:115], v[114:115], s[46:47] op_sel_hi:[1,0]
    s_nop 2
    v_pk_mul_f32 v[116:117], v[116:117], s[46:47] op_sel_hi:[1,0]
    v_pk_mul_f32 v[118:119], v[118:119], s[46:47] op_sel_hi:[1,0]
    s_branch K_NOU
K_Q:
    ds_read_b128 v[0:3], v120 offset:9472
    ds_read_b128 v[4:7], v121 offset:9472
    ds_read_b128 v[8:11], v122 offset:9472
    ds_read_b128 v[68:71], v123 offset:9472
    s_waitcnt lgkmcnt(4)
    v_mfma_f32_16x16x32_bf16 v[112:115], v[52:55], v[16:19], 0
    v_mfma_f32_16x16x32_bf16 v[112:115], v[56:59], v[20:23], v[112:115]
    v_mfma_f32_16x16x32_bf16 v[112:115], v[60:63], v[24:27], v[112:115]
    v_mfma_f32_16x16x32_bf16 v[112:115], v[64:67], v[28:31], v[112:115]
    ds_read_b128 v[52:55], v120 offset:13568
    ds_read_b128 v[56:59], v121 offset:13568
    ds_read_b128 v[60:63], v122 offset:13568
    ds_read_b128 v[64:67], v123 offset:13568
    s_waitcnt lgkmcnt(4)
    v_mfma_f32_16x16x32_bf16 v[116:119], v[0:3], v[16:19], 0
    v_mfma_f32_16x16x32_bf16 v[116:119], v[4:7], v[20:23], v[116:119]
    v_mfma_f32_16x16x32_bf16 v[116:119], v[8:11], v[24:27], v[116:119]
    v_mfma_f32_16x16x32_bf16 v[116:119], v[68:71], v[28:31], v[116:119]
    s_waitcnt lgkmcnt(0)
    v_subrev_u32 v92, 32768, v92
    v_mfma_f32_16x16x32_bf16 v[88:91], v[52:55], v[16:19], 0
    v_mfma_f32_16x16x32_bf16 v[88:91], v[56:59], v[20:23], v[88:91]
    v_mfma_f32_16x16x32_bf16 v[88:91], v[60:63], v[24:27], v[88:91]
    v_mfma_f32_16x16x32_bf16 v[88:91], v[64:67], v[28:31], v[88:91]
    ds_read_b64_tr_b16 v[16:17], v92 offset:0
    ds_read_b64_tr_b16 v[18:19], v92 offset:1024
    ds_read_b64_tr_b16 v[20:21], v92 offset:8192
    ds_read_b64_tr_b16 v[22:23], v92 offset:9216
    ds_read_b64_tr_b16 v[24:25], v92 offset:16384
    ds_read_b64_tr_b16 v[26:27], v92 offset:17408
    ds_read_b64_tr_b16 v[28:29], v92 offset:24576
    ds_read_b64_tr_b16 v[30:31], v92 offset:25600
    v_pk_mul_f32 v[112:113], v[112:113], s[46:47] op_sel_hi:[1,0]
    v_pk_mul_f32 v[114:115], v[114:115], s[46:47] op_sel_hi:[1,0]
    ds_write_b32 v104, v112 offset:16128
    ds_write_b32 v104, v113 offset:16640
    ds_write_b32 v104, v114 offset:17152
    ds_write_b32 v104, v115 offset:17664
    v_pk_mul_f32 v[116:117], v[116:117], s[46:47] op_sel_hi:[1,0]
    v_pk_mul_f32 v[118:119], v[118:119], s[46:47] op_sel_hi:[1,0]
    ds_write_b32 v104, v116 offset:24320
    ds_write_b32 v104, v117 offset:24832
    ds_write_b32 v104, v118 offset:25344
    ds_write_b32 v104, v119 offset:25856
    v_pk_mul_f32 v[88:89], v[88:89], s[46:47] op_sel_hi:[1,0]
    v_pk_mul_f32 v[90:91], v[90:91], s[46:47] op_sel_hi:[1,0]
    s_mov_b32 exec_hi, 0
    ds_write_b32 v104, v88 offset:32512
    ds_write_b32 v104, v89 offset:33024
    ds_write_b32 v104, v90 offset:33536
    ds_write_b32 v104, v91 offset:34048
    s_mov_b64 exec, -1
    s_waitcnt lgkmcnt(12)
    v_mfma_f32_16x16x32_bf16 v[112:115], v[16:19], v[0:3], 0
    v_mfma_f32_16x16x32_bf16 v[112:115], v[20:23], v[4:7], v[112:115]
    v_mfma_f32_16x16x32_bf16 v[112:115], v[24:27], v[8:11], v[112:115]
    v_mfma_f32_16x16x32_bf16 v[112:115], v[28:31], v[68:71], v[112:115]
    s_nop 7
    v_pk_mul_f32 v[112:113], v[112:113], s[46:47] op_sel_hi:[1,0]
    v_pk_mul_f32 v[114:115], v[114:115], s[46:47] op_sel_hi:[1,0]
K_NOU:
    s_waitcnt vmcnt(0)
    s_mov_b64 exec, s[50:51]
    v_lshrrev_b32 v0, 16, v34
    ds_add_rtn_u32 v35, v0, v13 offset:0
    s_mov_b64 exec, s[52:53]
    v_lshrrev_b32 v1, 16, v38
    ds_add_rtn_u32 v39, v1, v13 offset:0
    s_mov_b64 exec, s[54:55]
    s_cbranch_execz K_HD
    v_lshrrev_b32 v2, 16, v42
    ds_add_rtn_u32 v43, v2, v13 offset:0
    s_mov_b64 exec, s[56:57]
    s_cbranch_execz K_HD
    v_lshrrev_b32 v3, 16, v46
    ds_add_rtn_u32 v47, v3, v13 offset:0
    s_mov_b64 exec, s[58:59]
    s_cbranch_execz K_HD
    v_lshrrev_b32 v4, 16, v50
    ds_add_rtn_u32 v51, v4, v13 offset:0
K_HD:
    s_mov_b64 exec, 0xfff
    global_load_dword v63, v12, s[20:21] sc1
    s_mov_b64 exec, -1
    s_waitcnt lgkmcnt(0)
    s_barrier
    v_mov_b32 v9, 0
    ds_read_b32 v8, v14 offset:0
    ds_read_b32 v12, v9 offset:256
    s_waitcnt lgkmcnt(1)
    v_add_u32 v10, 7, v8
    v_lshrrev_b32 v11, 3, v10
    v_cmp_ne_u32 s[32:33], 0, v8
    v_and_b32 v107, 7, v10
    v_add_u32_dpp v11, v11, v11 row_shr:1 row_mask:0xf bank_mask:0xf bound_ctrl:0
    v_and_b32 v10, -8, v10
    v_add_u32 v107, 1, v107
    v_add_u32_dpp v11, v11, v11 row_shr:2 row_mask:0xf bank_mask:0xf bound_ctrl:0
    s_nop 1
    v_add_u32_dpp v11, v11, v11 row_shr:4 row_mask:0xf bank_mask:0xf bound_ctrl:0
    s_nop 1
    v_add_u32_dpp v11, v11, v11 row_shr:8 row_mask:0xf bank_mask:0xf bound_ctrl:0
    s_nop 1
    v_add_u32_dpp v11, v11, v11 row_bcast:15 row_mask:0xa bank_mask:0xf
    s_nop 1
    v_add_u32_dpp v11, v11, v11 row_bcast:31 row_mask:0xc bank_mask:0xf
    v_lshlrev_b32 v15, 3, v11
    v_sub_u32 v15, v15, v10
    ds_bpermute_b32 v16, v0, v15
    ds_bpermute_b32 v17, v1, v15
    v_readlane_b32 s44, v11, 63
    s_waitcnt lgkmcnt(2)
    v_readfirstlane_b32 s45, v12
    s_cmp_eq_u64 s[54:55], 0
    s_cbranch_scc1 K_BD
    ds_bpermute_b32 v18, v2, v15
    s_cmp_eq_u64 s[56:57], 0
    s_cbranch_scc1 K_BD
    ds_bpermute_b32 v19, v3, v15
    s_cmp_eq_u64 s[58:59], 0
    s_cbranch_scc1 K_BD
    ds_bpermute_b32 v20, v4, v15
K_BD:
    s_cmp_gt_u32 s44, 256
    s_cbranch_scc1 K_SHRINK
    s_or_b32 s9, s9, s45
    s_mul_i32 s70, s44, s42
    s_add_u32 s44, s70, s44
    s_lshr_b32 s70, s70, 4
    s_lshr_b32 s44, s44, 4
    v_cmp_ge_u32 vcc, s70, v11
    s_sub_u32 s10, s44, s70
    s_cmp_lg_u32 s22, 15
    s_cbranch_scc1 K_NOTF
    s_mov_b64 exec, s[32:33]
    ds_write_b8 v11, v13 offset:511
    s_mov_b64 exec, -1
    s_not_b64 s[46:47], s[32:33]
    s_and_b32 s47, s47, 0xff
K_ZL:
    s_ff1_i32_b64 s44, s[46:47]
    s_cmp_lt_i32 s44, 0
    s_cbranch_scc1 K_NOTF
    s_bitset0_b64 s[46:47], s44
    s_mul_i32 s44, s44, 272
    v_xor_b32 v10, s44, v82
    ds_write_b32 v10, v9 offset:5376
    s_branch K_ZL
K_NOTF:
    s_waitcnt lgkmcnt(0)
    s_mov_b64 exec, s[50:51]
    v_add_lshl_u32 v10, v16, v35, 3
    v_add_lshl_u32 v9, v16, v35, 1
    ds_write_b64 v10, v[32:33] offset:36608
    ds_write_b16 v9, v34 offset:1024
    s_mov_b64 exec, s[52:53]
    v_add_lshl_u32 v10, v17, v39, 3
    v_add_lshl_u32 v9, v17, v39, 1
    ds_write_b64 v10, v[36:37] offset:36608
    ds_write_b16 v9, v38 offset:1024
    s_mov_b64 exec, s[54:55]
    s_cbranch_execz K_SD
    v_add_lshl_u32 v10, v18, v43, 3
    v_add_lshl_u32 v9, v18, v43, 1
    ds_write_b64 v10, v[40:41] offset:36608
    ds_write_b16 v9, v42 offset:1024
    s_mov_b64 exec, s[56:57]
    s_cbranch_execz K_SD
    v_add_lshl_u32 v10, v19, v47, 3
    v_add_lshl_u32 v9, v19, v47, 1
    ds_write_b64 v10, v[44:45] offset:36608
    ds_write_b16 v9, v46 offset:1024
    s_mov_b64 exec, s[58:59]
    s_cbranch_execz K_SD
    v_add_lshl_u32 v10, v20, v51, 3
    v_add_lshl_u32 v9, v20, v51, 1
    ds_write_b64 v10, v[48:49] offset:36608
    ds_write_b16 v9, v50 offset:1024
K_SD:
    s_mov_b64 exec, -1
    s_bcnt1_i32_b64 s15, vcc
    s_min_u32 s15, s15, 61
    s_or_b32 s33, s33, 0xc0000000
    s_lshr_b64 s[32:33], s[32:33], s15
    s_lshl_b64 s[32:33], s[32:33], s15
    s_mov_b64 s[18:19], s[32:33]
    s_mov_b32 s16, s15
    v_readlane_b32 s44, v15, s15
    s_lshl_b32 s45, s70, 3
    s_cmp_eq_u32 s9, 0
    s_cselect_b32 s48, 63, s22
    s_sub_u32 s68, s45, s44
    v_lshl_add_u32 v97, s70, 6, v111
    v_lshl_add_u32 v98, s70, 4, v81
    v_lshrrev_b32 v9, 2, v14
    v_add_u32 v9, s70, v9
    s_waitcnt lgkmcnt(0)
    s_barrier
    ds_read_u16 v100, v98 offset:1024
    ds_read_u16 v102, v98 offset:1032
    ds_read_u8 v16, v9 offset:512
    s_setprio 3
    s_cmp_eq_u32 s10, 0
    s_cbranch_scc1 K_MAINDONE
    s_cmp_lg_u32 s9, 0
    s_cbranch_scc1 S_START
F_START:
    s_waitcnt lgkmcnt(1)
    s_mov_b32 m0, s40
    s_nop 0
    buffer_load_dwordx4 v[100:101], s[24:27], 0 idxen offen sc1 lds
    buffer_load_dwordx4 v[102:103], s[64:67], 0 idxen offen offset:1024 sc1 lds
    ds_read_u16 v100, v98 offset:1040
    ds_read_u16 v102, v98 offset:1048
    v_lshl_add_u32 v104, s16, 9, v106
    ds_read_b64 v[32:33], v104 offset:16128
    ds_read_b64 v[34:35], v104 offset:16128
    ds_read_b64 v[36:37], v104 offset:16128
    ds_read_b64 v[38:39], v104 offset:16128
    ds_read_b64 v[40:41], v104 offset:16128
    ds_read_b64 v[42:43], v104 offset:16128
    ds_read_b64 v[44:45], v104 offset:16128
    ds_read_b64 v[46:47], v104 offset:16128
    s_waitcnt lgkmcnt(8)
    v_cmp_ne_u32 vcc, 0, v16
    s_mov_b32 m0, s41
    s_nop 0
    buffer_load_dwordx4 v[100:101], s[24:27], 0 idxen offen sc1 lds
    buffer_load_dwordx4 v[102:103], s[64:67], 0 idxen offen offset:1024 sc1 lds
    ds_read_u16 v100, v98 offset:1056
    ds_read_u16 v102, v98 offset:1064
    s_mov_b64 exec, s[34:35]
    ds_read_b64 v[72:73], v97 offset:36608
    s_mov_b64 exec, s[36:37]
    ds_read_b64 v[74:75], v97 offset:36608
    s_mov_b64 exec, -1
    s_brev_b32 s12, vcc_lo
    s_lshl_b32 s13, s12, 1
    s_sub_u32 s44, 32, s10
    s_lshr_b32 s14, s12, s44
    s_lshl_b32 s12, s14, s44
    s_sub_u32 s44, s44, 1
    s_lshl_b32 s44, 79, s44
    s_or_b32 s12, s12, s44
    s_waitcnt vmcnt(2)
    ds_read_b64 v[64:65], v99 offset:0
    ds_read_b64 v[66:67], v99 offset:512
    ds_read_b64 v[68:69], v99 offset:1024
    ds_read_b64 v[70:71], v99 offset:1536
    s_waitcnt lgkmcnt(0)
    s_mov_b32 m0, s40
    s_nop 0
    buffer_load_dwordx4 v[100:101], s[24:27], 0 idxen offen sc1 lds
    buffer_load_dwordx4 v[102:103], s[64:67], 0 idxen offen offset:1024 sc1 lds
    v_mfma_f32_32x32x16_bf16 v[0:15], v[72:75], v[84:87], v[32:47]
    v_smfmac_f32_32x32x32_bf16 v[0:15], v[76:79], v[64:71], v80
    s_mov_b64 exec, s[34:35]
    ds_read_b64 v[72:73], v97 offset:36672
    s_mov_b64 exec, s[36:37]
    ds_read_b64 v[74:75], v97 offset:36672
    s_mov_b64 exec, -1
    ds_read_u16 v100, v98 offset:1072
    ds_read_u16 v102, v98 offset:1080
    s_bitcmp0_b32 vcc_lo, 0
    s_cbranch_scc1 F_S4
    s_bitset0_b64 s[32:33], s16
    s_ff1_i32_b64 s16, s[32:33]
    v_lshl_add_u32 v104, s16, 9, v106
    ds_read_b64 v[32:33], v104 offset:16128
    ds_read_b64 v[34:35], v104 offset:16128
    ds_read_b64 v[36:37], v104 offset:16128
    ds_read_b64 v[38:39], v104 offset:16128
    ds_read_b64 v[40:41], v104 offset:16128
    ds_read_b64 v[42:43], v104 offset:16128
    ds_read_b64 v[44:45], v104 offset:16128
    ds_read_b64 v[46:47], v104 offset:16128
F_S4:
    s_waitcnt vmcnt(2)
    ds_read_b64 v[64:65], v99 offset:2048
    ds_read_b64 v[66:67], v99 offset:2560
    ds_read_b64 v[68:69], v99 offset:3072
    ds_read_b64 v[70:71], v99 offset:3584
    s_branch F_G0B
F_TAIL0:
    s_setprio 2
    s_cmp_ge_u32 s10, 3
    s_cbranch_scc1 F_TD0
    s_setprio 1
    s_cmp_gt_u32 s10, 0
    s_cbranch_scc1 F_T10
    s_setprio 0
F_T10:
    s_waitcnt vmcnt(0)
    s_branch F_T20
F_TD0:
    s_mov_b32 m0, s41
    s_nop 0
    buffer_load_dwordx4 v[100:101], s[24:27], 0 idxen offen sc1 lds
    buffer_load_dwordx4 v[102:103], s[64:67], 0 idxen offen offset:1024 sc1 lds
F_T20:
    s_bitcmp1_b32 s14, s10
    s_cbranch_scc1 F_ENDN0
    s_cmp_eq_u32 s10, 0
    s_cbranch_scc1 F_RE0
    s_add_u32 s13, s13, s13
    s_branch F_XB0
F_RE0:
    s_mov_b32 s11, 8
    s_mov_b32 s69, s15
    s_mov_b32 s68, 1
    s_branch F_X0_8
F_FA0:
    v_lshl_add_u32 v105, s69, 10, v106
    v_cvt_f64_f32 v[48:49], v88
    v_cvt_f64_f32 v[50:51], v89
    v_pk_fma_f32 v[94:95], v[88:89], 0, v[94:95] op_sel_hi:[1,0,1]
    ds_add_f64 v105, v[48:49] offset:52992
    ds_add_f64 v105, v[50:51] offset:53504
    s_bitcmp1_b32 s14, s10
    s_cselect_b32 s48, s69, s48
    s_mov_b32 s68, 0
    s_branch F_FB0
F_ADVP0:
    s_bitset0_b64 s[32:33], s16
    s_ff1_i32_b64 s16, s[32:33]
    v_lshl_add_u32 v104, s16, 9, v106
    ds_read_b64 v[32:33], v104 offset:16128
    ds_read_b64 v[34:35], v104 offset:16128
    ds_read_b64 v[36:37], v104 offset:16128
    ds_read_b64 v[38:39], v104 offset:16128
    ds_read_b64 v[40:41], v104 offset:16128
    ds_read_b64 v[42:43], v104 offset:16128
    ds_read_b64 v[44:45], v104 offset:16128
    ds_read_b64 v[46:47], v104 offset:16128
    s_branch F_RBP0
F_ADVE0:
    s_bitset0_b64 s[32:33], s16
    s_ff1_i32_b64 s16, s[32:33]
    v_lshl_add_u32 v104, s16, 9, v106
    ds_read_b64 v[32:33], v104 offset:16128
    ds_read_b64 v[34:35], v104 offset:16128
    ds_read_b64 v[36:37], v104 offset:16128
    ds_read_b64 v[38:39], v104 offset:16128
    ds_read_b64 v[40:41], v104 offset:16128
    ds_read_b64 v[42:43], v104 offset:16128
    ds_read_b64 v[44:45], v104 offset:16128
    ds_read_b64 v[46:47], v104 offset:16128
    s_branch F_RBE0
F_XD0:
    s_cmp_gt_u32 s11, 3
    s_cbranch_scc1 F_XD0_H
    s_cmp_eq_u32 s11, 2
    s_cbranch_scc1 F_XS0_2
    s_cmp_eq_u32 s11, 3
    s_cbranch_scc1 F_XS0_3
    s_branch F_XS0_1
F_XD0_H:
    s_cmp_gt_u32 s11, 5
    s_cbranch_scc1 F_XD0_HH
    s_cmp_eq_u32 s11, 4
    s_cbranch_scc1 F_XS0_4
    s_branch F_XS0_5
F_XD0_HH:
    s_cmp_eq_u32 s11, 6
    s_cbranch_scc1 F_XS0_6
    s_branch F_XS0_7
F_XS0_1:
    v_mfma_f32_32x32x16_bf16 v[16:31], v[72:75], v[84:87], v[32:47]
    v_smfmac_f32_32x32x32_bf16 v[16:31], v[76:79], v[64:71], v80
    s_branch F_X0_1
F_XS0_2:
    v_mfma_f32_32x32x16_bf16 v[16:31], v[72:75], v[84:87], v[32:47]
    v_smfmac_f32_32x32x32_bf16 v[16:31], v[76:79], v[64:71], v80
    s_branch F_X0_2
F_XS0_3:
    v_mfma_f32_32x32x16_bf16 v[16:31], v[72:75], v[84:87], v[32:47]
    s_branch F_X0_3
F_XS0_4:
    v_mfma_f32_32x32x16_bf16 v[16:31], v[72:75], v[84:87], v[32:47]
    s_branch F_X0_4
F_XS0_5:
    v_mfma_f32_32x32x16_bf16 v[16:31], v[72:75], v[84:87], v[32:47]
    s_branch F_X0_5
F_XS0_6:
    v_mfma_f32_32x32x16_bf16 v[16:31], v[72:75], v[84:87], v[32:47]
    s_branch F_X0_6
F_XS0_7:
    v_mfma_f32_32x32x16_bf16 v[16:31], v[72:75], v[84:87], v[32:47]
    s_branch F_X0_7
F_YD0:
    s_cmp_gt_u32 s11, 3
    s_cbranch_scc1 F_YD0_H
    s_cmp_eq_u32 s11, 2
    s_cbranch_scc1 F_Y0_2
    s_cmp_eq_u32 s11, 3
    s_cbranch_scc1 F_Y0_3
    s_branch F_Y0_1
F_YD0_H:
    s_cmp_gt_u32 s11, 5
    s_cbranch_scc1 F_YD0_HH
    s_cmp_eq_u32 s11, 4
    s_cbranch_scc1 F_Y0_4
    s_branch F_Y0_5
F_YD0_HH:
    s_cmp_eq_u32 s11, 6
    s_cbranch_scc1 F_Y0_6
    s_branch F_Y0_7
F_SP0:
    s_ff1_i32_b32 s10, s12
    s_sub_u32 s10, 31, s10
    s_cmp_le_u32 s10, 5
    s_cbranch_scc1 F_TAIL0
    s_mov_b32 m0, s41
    s_nop 0
    buffer_load_dwordx4 v[100:101], s[24:27], 0 idxen offen sc1 lds
    buffer_load_dwordx4 v[102:103], s[64:67], 0 idxen offen offset:1024 sc1 lds
F_ENDN0:
    v_readlane_b32 s11, v107, s15
    s_mov_b32 s69, s15
    s_bitset0_b64 s[18:19], s15
    s_ff1_i32_b64 s15, s[18:19]
    s_cmp_lt_u32 s11, 8
    s_cbranch_scc1 F_XD0
F_X0_8:
    v_mfma_f32_32x32x16_bf16 v[16:31], v[72:75], v[84:87], v[32:47]
    v_exp_f32 v63, v15
    v_exp_f32 v62, v14
F_X0_7:
    v_exp_f32 v61, v13
    v_exp_f32 v60, v12
F_X0_6:
    v_exp_f32 v59, v11
    v_exp_f32 v58, v10
F_X0_5:
    v_exp_f32 v57, v9
    v_exp_f32 v56, v8
F_X0_4:
    v_exp_f32 v55, v7
    v_exp_f32 v54, v6
F_X0_3:
    v_smfmac_f32_32x32x32_bf16 v[16:31], v[76:79], v[64:71], v80
    v_exp_f32 v53, v5
    v_exp_f32 v52, v4
F_X0_2:
    v_exp_f32 v51, v3
    v_exp_f32 v50, v2
F_X0_1:
    v_exp_f32 v49, v1
    v_exp_f32 v48, v0
    s_waitcnt vmcnt(2)
    ds_read_b64 v[64:65], v99 offset:0
    ds_read_b64 v[66:67], v99 offset:512
    ds_read_b64 v[68:69], v99 offset:1024
    ds_read_b64 v[70:71], v99 offset:1536
    s_add_u32 s13, s13, s13
    s_cbranch_scc1 F_ADVE0
F_RBE0:
    s_mov_b64 exec, s[34:35]
    ds_read_b64 v[72:73], v97 offset:36736
    s_mov_b64 exec, s[36:37]
    ds_read_b64 v[74:75], v97 offset:36736
    s_mov_b64 exec, -1
    ds_read_u16 v100, v98 offset:1088
    ds_read_u16 v102, v98 offset:1096
    s_cmp_lt_u32 s11, 8
    s_cbranch_scc1 F_YD0
    v_pk_fma_f32 v[88:89], v[14:15], v[92:93], v[90:91]
    v_pk_fma_f32 v[92:93], v[92:93], v[62:63], v[92:93]
    v_pk_fma_f32 v[90:91], v[90:91], v[62:63], v[88:89]
F_Y0_7:
    v_pk_fma_f32 v[88:89], v[12:13], v[92:93], v[90:91]
    v_pk_fma_f32 v[92:93], v[92:93], v[60:61], v[92:93]
    v_pk_fma_f32 v[90:91], v[90:91], v[60:61], v[88:89]
F_Y0_6:
    v_pk_fma_f32 v[88:89], v[10:11], v[92:93], v[90:91]
    v_pk_fma_f32 v[92:93], v[92:93], v[58:59], v[92:93]
    v_pk_fma_f32 v[90:91], v[90:91], v[58:59], v[88:89]
F_Y0_5:
    v_pk_fma_f32 v[88:89], v[8:9], v[92:93], v[90:91]
    v_pk_fma_f32 v[92:93], v[92:93], v[56:57], v[92:93]
    v_pk_fma_f32 v[90:91], v[90:91], v[56:57], v[88:89]
F_Y0_4:
    v_pk_fma_f32 v[88:89], v[6:7], v[92:93], v[90:91]
    v_pk_fma_f32 v[92:93], v[92:93], v[54:55], v[92:93]
    v_pk_fma_f32 v[90:91], v[90:91], v[54:55], v[88:89]
F_Y0_3:
    v_pk_fma_f32 v[88:89], v[4:5], v[92:93], v[90:91]
    v_pk_fma_f32 v[92:93], v[92:93], v[52:53], v[92:93]
    v_pk_fma_f32 v[90:91], v[90:91], v[52:53], v[88:89]
F_Y0_2:
    v_pk_fma_f32 v[88:89], v[2:3], v[92:93], v[90:91]
    v_pk_fma_f32 v[92:93], v[92:93], v[50:51], v[92:93]
    v_pk_fma_f32 v[90:91], v[90:91], v[50:51], v[88:89]
F_Y0_1:
    v_pk_fma_f32 v[88:89], v[0:1], v[92:93], v[90:91]
    v_pk_fma_f32 v[92:93], v[92:93], v[48:49], v[92:93]
    v_pk_fma_f32 v[90:91], v[90:91], v[48:49], v[88:89]
    v_rcp_f32 v48, v92
    v_rcp_f32 v49, v93
    v_max3_f32 v96, v96, v92, v93
    v_pk_mul_f32 v[88:89], v[90:91], v[48:49]
    s_cmp_lg_u32 s68, 0
    s_cbranch_scc1 F_FA0
    s_mul_i32 s44, s69, 272
    v_cvt_pk_bf16_f32 v48, v88, v89
    v_xor_b32 v105, s44, v82
    v_pk_fma_f32 v[94:95], v[88:89], 0, v[94:95] op_sel_hi:[1,0,1]
    ds_write_b32 v105, v48 offset:5376
F_FB0:
    s_cmp_eq_u32 s10, 0
    s_cbranch_scc1 K_MAINDONE
    s_branch F_G1
F_GS0:
    v_mov_b64 v[92:93], s[38:39]
    v_mov_b64 v[90:91], 0
    s_branch F_SP0
F_ADVG0:
    s_bitset0_b64 s[32:33], s16
    s_ff1_i32_b64 s16, s[32:33]
    v_lshl_add_u32 v104, s16, 9, v106
    ds_read_b64 v[32:33], v104 offset:16128
    ds_read_b64 v[34:35], v104 offset:16128
    ds_read_b64 v[36:37], v104 offset:16128
    ds_read_b64 v[38:39], v104 offset:16128
    ds_read_b64 v[40:41], v104 offset:16128
    ds_read_b64 v[42:43], v104 offset:16128
    ds_read_b64 v[44:45], v104 offset:16128
    ds_read_b64 v[46:47], v104 offset:16128
    s_branch F_RBG0
F_G0:
    v_add_u32 v97, 128, v97
    v_add_u32 v98, 32, v98
F_G0B:
    s_add_u32 s12, s12, s12
    s_waitcnt lgkmcnt(0)
    s_cbranch_scc1 F_GS0
    s_mov_b32 m0, s41
    s_add_u32 s13, s13, s13
    buffer_load_dwordx4 v[100:101], s[24:27], 0 idxen offen sc1 lds
    buffer_load_dwordx4 v[102:103], s[64:67], 0 idxen offen offset:1024 sc1 lds
    v_mfma_f32_32x32x16_bf16 v[16:31], v[72:75], v[84:87], v[32:47]
    v_exp_f32 v63, v15
    v_exp_f32 v62, v14
    v_exp_f32 v61, v13
    v_exp_f32 v60, v12
    v_exp_f32 v59, v11
    v_exp_f32 v58, v10
    v_exp_f32 v57, v9
    v_exp_f32 v56, v8
    v_exp_f32 v55, v7
    v_exp_f32 v54, v6
    v_smfmac_f32_32x32x32_bf16 v[16:31], v[76:79], v[64:71], v80
    v_exp_f32 v53, v5
    v_exp_f32 v52, v4
    v_exp_f32 v51, v3
    v_exp_f32 v50, v2
    v_exp_f32 v49, v1
    v_exp_f32 v48, v0
    s_waitcnt vmcnt(2)
    ds_read_b64 v[64:65], v99 offset:0
    ds_read_b64 v[66:67], v99 offset:512
    ds_read_b64 v[68:69], v99 offset:1024
    ds_read_b64 v[70:71], v99 offset:1536
    s_cbranch_scc1 F_ADVG0
F_RBG0:
    s_mov_b64 exec, s[34:35]
    ds_read_b64 v[72:73], v97 offset:36736
    s_mov_b64 exec, s[36:37]
    ds_read_b64 v[74:75], v97 offset:36736
    s_mov_b64 exec, -1
    ds_read_u16 v100, v98 offset:1088
    ds_read_u16 v102, v98 offset:1096
    v_pk_add_f32 v[92:93], v[62:63], 1.0 op_sel_hi:[1,0]
    v_pk_fma_f32 v[88:89], v[12:13], v[92:93], v[14:15]
    v_pk_fma_f32 v[92:93], v[92:93], v[60:61], v[92:93]
    v_pk_fma_f32 v[90:91], v[14:15], v[60:61], v[88:89]
    s_branch F_YP0_6
F_TAIL1:
    s_setprio 2
    s_cmp_ge_u32 s10, 3
    s_cbranch_scc1 F_TD1
    s_setprio 1
    s_cmp_gt_u32 s10, 0
    s_cbranch_scc1 F_T11
    s_setprio 0
F_T11:
    s_waitcnt vmcnt(0)
    s_branch F_T21
F_TD1:
    s_mov_b32 m0, s40
    s_nop 0
    buffer_load_dwordx4 v[100:101], s[24:27], 0 idxen offen sc1 lds
    buffer_load_dwordx4 v[102:103], s[64:67], 0 idxen offen offset:1024 sc1 lds
F_T21:
    s_bitcmp1_b32 s14, s10
    s_cbranch_scc1 F_ENDN1
    s_cmp_eq_u32 s10, 0
    s_cbranch_scc1 F_RE1
    s_add_u32 s13, s13, s13
    s_branch F_XB1
F_RE1:
    s_mov_b32 s11, 8
    s_mov_b32 s69, s15
    s_mov_b32 s68, 1
    s_branch F_X1_8
F_FA1:
    v_lshl_add_u32 v105, s69, 10, v106
    v_cvt_f64_f32 v[48:49], v88
    v_cvt_f64_f32 v[50:51], v89
    v_pk_fma_f32 v[94:95], v[88:89], 0, v[94:95] op_sel_hi:[1,0,1]
    ds_add_f64 v105, v[48:49] offset:52992
    ds_add_f64 v105, v[50:51] offset:53504
    s_bitcmp1_b32 s14, s10
    s_cselect_b32 s48, s69, s48
    s_mov_b32 s68, 0
    s_branch F_FB1
F_ADVP1:
    s_bitset0_b64 s[32:33], s16
    s_ff1_i32_b64 s16, s[32:33]
    v_lshl_add_u32 v104, s16, 9, v106
    ds_read_b64 v[32:33], v104 offset:16128
    ds_read_b64 v[34:35], v104 offset:16128
    ds_read_b64 v[36:37], v104 offset:16128
    ds_read_b64 v[38:39], v104 offset:16128
    ds_read_b64 v[40:41], v104 offset:16128
    ds_read_b64 v[42:43], v104 offset:16128
    ds_read_b64 v[44:45], v104 offset:16128
    ds_read_b64 v[46:47], v104 offset:16128
    s_branch F_RBP1
F_ADVE1:
    s_bitset0_b64 s[32:33], s16
    s_ff1_i32_b64 s16, s[32:33]
    v_lshl_add_u32 v104, s16, 9, v106
    ds_read_b64 v[32:33], v104 offset:16128
    ds_read_b64 v[34:35], v104 offset:16128
    ds_read_b64 v[36:37], v104 offset:16128
    ds_read_b64 v[38:39], v104 offset:16128
    ds_read_b64 v[40:41], v104 offset:16128
    ds_read_b64 v[42:43], v104 offset:16128
    ds_read_b64 v[44:45], v104 offset:16128
    ds_read_b64 v[46:47], v104 offset:16128
    s_branch F_RBE1
F_XD1:
    s_cmp_gt_u32 s11, 3
    s_cbranch_scc1 F_XD1_H
    s_cmp_eq_u32 s11, 2
    s_cbranch_scc1 F_XS1_2
    s_cmp_eq_u32 s11, 3
    s_cbranch_scc1 F_XS1_3
    s_branch F_XS1_1
F_XD1_H:
    s_cmp_gt_u32 s11, 5
    s_cbranch_scc1 F_XD1_HH
    s_cmp_eq_u32 s11, 4
    s_cbranch_scc1 F_XS1_4
    s_branch F_XS1_5
F_XD1_HH:
    s_cmp_eq_u32 s11, 6
    s_cbranch_scc1 F_XS1_6
    s_branch F_XS1_7
F_XS1_1:
    v_mfma_f32_32x32x16_bf16 v[0:15], v[72:75], v[84:87], v[32:47]
    v_smfmac_f32_32x32x32_bf16 v[0:15], v[76:79], v[64:71], v80
    s_branch F_X1_1
F_XS1_2:
    v_mfma_f32_32x32x16_bf16 v[0:15], v[72:75], v[84:87], v[32:47]
    v_smfmac_f32_32x32x32_bf16 v[0:15], v[76:79], v[64:71], v80
    s_branch F_X1_2
F_XS1_3:
    v_mfma_f32_32x32x16_bf16 v[0:15], v[72:75], v[84:87], v[32:47]
    s_branch F_X1_3
F_XS1_4:
    v_mfma_f32_32x32x16_bf16 v[0:15], v[72:75], v[84:87], v[32:47]
    s_branch F_X1_4
F_XS1_5:
    v_mfma_f32_32x32x16_bf16 v[0:15], v[72:75], v[84:87], v[32:47]
    s_branch F_X1_5
F_XS1_6:
    v_mfma_f32_32x32x16_bf16 v[0:15], v[72:75], v[84:87], v[32:47]
    s_branch F_X1_6
F_XS1_7:
    v_mfma_f32_32x32x16_bf16 v[0:15], v[72:75], v[84:87], v[32:47]
    s_branch F_X1_7
F_YD1:
    s_cmp_gt_u32 s11, 3
    s_cbranch_scc1 F_YD1_H
    s_cmp_eq_u32 s11, 2
    s_cbranch_scc1 F_Y1_2
    s_cmp_eq_u32 s11, 3
    s_cbranch_scc1 F_Y1_3
    s_branch F_Y1_1
F_YD1_H:
    s_cmp_gt_u32 s11, 5
    s_cbranch_scc1 F_YD1_HH
    s_cmp_eq_u32 s11, 4
    s_cbranch_scc1 F_Y1_4
    s_branch F_Y1_5
F_YD1_HH:
    s_cmp_eq_u32 s11, 6
    s_cbranch_scc1 F_Y1_6
    s_branch F_Y1_7
F_SP1:
    s_ff1_i32_b32 s10, s12
    s_sub_u32 s10, 31, s10
    s_cmp_le_u32 s10, 5
    s_cbranch_scc1 F_TAIL1
    s_mov_b32 m0, s40
    s_nop 0
    buffer_load_dwordx4 v[100:101], s[24:27], 0 idxen offen sc1 lds
    buffer_load_dwordx4 v[102:103], s[64:67], 0 idxen offen offset:1024 sc1 lds
F_ENDN1:
    v_readlane_b32 s11, v107, s15
    s_mov_b32 s69, s15
    s_bitset0_b64 s[18:19], s15
    s_ff1_i32_b64 s15, s[18:19]
    s_cmp_lt_u32 s11, 8
    s_cbranch_scc1 F_XD1
F_X1_8:
    v_mfma_f32_32x32x16_bf16 v[0:15], v[72:75], v[84:87], v[32:47]
    v_exp_f32 v63, v31
    v_exp_f32 v62, v30
F_X1_7:
    v_exp_f32 v61, v29
    v_exp_f32 v60, v28
F_X1_6:
    v_exp_f32 v59, v27
    v_exp_f32 v58, v26
F_X1_5:
    v_exp_f32 v57, v25
    v_exp_f32 v56, v24
F_X1_4:
    v_exp_f32 v55, v23
    v_exp_f32 v54, v22
F_X1_3:
    v_smfmac_f32_32x32x32_bf16 v[0:15], v[76:79], v[64:71], v80
    v_exp_f32 v53, v21
    v_exp_f32 v52, v20
F_X1_2:
    v_exp_f32 v51, v19
    v_exp_f32 v50, v18
F_X1_1:
    v_exp_f32 v49, v17
    v_exp_f32 v48, v16
    s_waitcnt vmcnt(2)
    ds_read_b64 v[64:65], v99 offset:2048
    ds_read_b64 v[66:67], v99 offset:2560
    ds_read_b64 v[68:69], v99 offset:3072
    ds_read_b64 v[70:71], v99 offset:3584
    s_add_u32 s13, s13, s13
    s_cbranch_scc1 F_ADVE1
F_RBE1:
    s_mov_b64 exec, s[34:35]
    ds_read_b64 v[72:73], v97 offset:36800
    s_mov_b64 exec, s[36:37]
    ds_read_b64 v[74:75], v97 offset:36800
    s_mov_b64 exec, -1
    ds_read_u16 v100, v98 offset:1104
    ds_read_u16 v102, v98 offset:1112
    s_cmp_lt_u32 s11, 8
    s_cbranch_scc1 F_YD1
    v_pk_fma_f32 v[88:89], v[30:31], v[92:93], v[90:91]
    v_pk_fma_f32 v[92:93], v[92:93], v[62:63], v[92:93]
    v_pk_fma_f32 v[90:91], v[90:91], v[62:63], v[88:89]
F_Y1_7:
    v_pk_fma_f32 v[88:89], v[28:29], v[92:93], v[90:91]
    v_pk_fma_f32 v[92:93], v[92:93], v[60:61], v[92:93]
    v_pk_fma_f32 v[90:91], v[90:91], v[60:61], v[88:89]
F_Y1_6:
    v_pk_fma_f32 v[88:89], v[26:27], v[92:93], v[90:91]
    v_pk_fma_f32 v[92:93], v[92:93], v[58:59], v[92:93]
    v_pk_fma_f32 v[90:91], v[90:91], v[58:59], v[88:89]
F_Y1_5:
    v_pk_fma_f32 v[88:89], v[24:25], v[92:93], v[90:91]
    v_pk_fma_f32 v[92:93], v[92:93], v[56:57], v[92:93]
    v_pk_fma_f32 v[90:91], v[90:91], v[56:57], v[88:89]
F_Y1_4:
    v_pk_fma_f32 v[88:89], v[22:23], v[92:93], v[90:91]
    v_pk_fma_f32 v[92:93], v[92:93], v[54:55], v[92:93]
    v_pk_fma_f32 v[90:91], v[90:91], v[54:55], v[88:89]
F_Y1_3:
    v_pk_fma_f32 v[88:89], v[20:21], v[92:93], v[90:91]
    v_pk_fma_f32 v[92:93], v[92:93], v[52:53], v[92:93]
    v_pk_fma_f32 v[90:91], v[90:91], v[52:53], v[88:89]
F_Y1_2:
    v_pk_fma_f32 v[88:89], v[18:19], v[92:93], v[90:91]
    v_pk_fma_f32 v[92:93], v[92:93], v[50:51], v[92:93]
    v_pk_fma_f32 v[90:91], v[90:91], v[50:51], v[88:89]
F_Y1_1:
    v_pk_fma_f32 v[88:89], v[16:17], v[92:93], v[90:91]
    v_pk_fma_f32 v[92:93], v[92:93], v[48:49], v[92:93]
    v_pk_fma_f32 v[90:91], v[90:91], v[48:49], v[88:89]
    v_rcp_f32 v48, v92
    v_rcp_f32 v49, v93
    v_max3_f32 v96, v96, v92, v93
    v_pk_mul_f32 v[88:89], v[90:91], v[48:49]
    s_cmp_lg_u32 s68, 0
    s_cbranch_scc1 F_FA1
    s_mul_i32 s44, s69, 272
    v_cvt_pk_bf16_f32 v48, v88, v89
    v_xor_b32 v105, s44, v82
    v_pk_fma_f32 v[94:95], v[88:89], 0, v[94:95] op_sel_hi:[1,0,1]
    ds_write_b32 v105, v48 offset:5376
F_FB1:
    s_cmp_eq_u32 s10, 0
    s_cbranch_scc1 K_MAINDONE
    s_branch F_G0
F_GS1:
    v_mov_b64 v[92:93], s[38:39]
    v_mov_b64 v[90:91], 0
    s_branch F_SP1
F_ADVG1:
    s_bitset0_b64 s[32:33], s16
    s_ff1_i32_b64 s16, s[32:33]
    v_lshl_add_u32 v104, s16, 9, v106
    ds_read_b64 v[32:33], v104 offset:16128
    ds_read_b64 v[34:35], v104 offset:16128
    ds_read_b64 v[36:37], v104 offset:16128
    ds_read_b64 v[38:39], v104 offset:16128
    ds_read_b64 v[40:41], v104 offset:16128
    ds_read_b64 v[42:43], v104 offset:16128
    ds_read_b64 v[44:45], v104 offset:16128
    ds_read_b64 v[46:47], v104 offset:16128
    s_branch F_RBG1
F_G1:
    s_add_u32 s12, s12, s12
    s_waitcnt lgkmcnt(0)
    s_cbranch_scc1 F_GS1
    s_mov_b32 m0, s40
    s_add_u32 s13, s13, s13
    buffer_load_dwordx4 v[100:101], s[24:27], 0 idxen offen sc1 lds
    buffer_load_dwordx4 v[102:103], s[64:67], 0 idxen offen offset:1024 sc1 lds
    v_mfma_f32_32x32x16_bf16 v[0:15], v[72:75], v[84:87], v[32:47]
    v_exp_f32 v63, v31
    v_exp_f32 v62, v30
    v_exp_f32 v61, v29
    v_exp_f32 v60, v28
    v_exp_f32 v59, v27
    v_exp_f32 v58, v26
    v_exp_f32 v57, v25
    v_exp_f32 v56, v24
    v_exp_f32 v55, v23
    v_exp_f32 v54, v22
    v_smfmac_f32_32x32x32_bf16 v[0:15], v[76:79], v[64:71], v80
    v_exp_f32 v53, v21
    v_exp_f32 v52, v20
    v_exp_f32 v51, v19
    v_exp_f32 v50, v18
    v_exp_f32 v49, v17
    v_exp_f32 v48, v16
    s_waitcnt vmcnt(2)
    ds_read_b64 v[64:65], v99 offset:2048
    ds_read_b64 v[66:67], v99 offset:2560
    ds_read_b64 v[68:69], v99 offset:3072
    ds_read_b64 v[70:71], v99 offset:3584
    s_cbranch_scc1 F_ADVG1
F_RBG1:
    s_mov_b64 exec, s[34:35]
    ds_read_b64 v[72:73], v97 offset:36800
    s_mov_b64 exec, s[36:37]
    ds_read_b64 v[74:75], v97 offset:36800
    s_mov_b64 exec, -1
    ds_read_u16 v100, v98 offset:1104
    ds_read_u16 v102, v98 offset:1112
    v_pk_add_f32 v[92:93], v[62:63], 1.0 op_sel_hi:[1,0]
    v_pk_fma_f32 v[88:89], v[28:29], v[92:93], v[30:31]
    v_pk_fma_f32 v[92:93], v[92:93], v[60:61], v[92:93]
    v_pk_fma_f32 v[90:91], v[30:31], v[60:61], v[88:89]
    s_branch F_YP1_6
    .p2align 6
F_L0:
    v_add_u32 v97, 128, v97
    v_add_u32 v98, 32, v98
F_L0B:
    s_add_u32 s12, s12, s12
    s_waitcnt lgkmcnt(0)
    s_cbranch_scc1 F_SP0
    s_mov_b32 m0, s41
    s_add_u32 s13, s13, s13
    buffer_load_dwordx4 v[100:101], s[24:27], 0 idxen offen sc1 lds
    buffer_load_dwordx4 v[102:103], s[64:67], 0 idxen offen offset:1024 sc1 lds
F_XB0:
    v_mfma_f32_32x32x16_bf16 v[16:31], v[72:75], v[84:87], v[32:47]
    v_exp_f32 v63, v15
    v_exp_f32 v62, v14
    v_exp_f32 v61, v13
    v_exp_f32 v60, v12
    v_exp_f32 v59, v11
    v_exp_f32 v58, v10
    v_exp_f32 v57, v9
    v_exp_f32 v56, v8
    v_exp_f32 v55, v7
    v_exp_f32 v54, v6
    v_smfmac_f32_32x32x32_bf16 v[16:31], v[76:79], v[64:71], v80
    v_exp_f32 v53, v5
    v_exp_f32 v52, v4
    v_exp_f32 v51, v3
    v_exp_f32 v50, v2
    v_exp_f32 v49, v1
    v_exp_f32 v48, v0
    s_waitcnt vmcnt(2)
    ds_read_b64 v[64:65], v99 offset:0
    ds_read_b64 v[66:67], v99 offset:512
    ds_read_b64 v[68:69], v99 offset:1024
    ds_read_b64 v[70:71], v99 offset:1536
    s_cbranch_scc1 F_ADVP0
F_RBP0:
    s_mov_b64 exec, s[34:35]
    ds_read_b64 v[72:73], v97 offset:36736
    s_mov_b64 exec, s[36:37]
    ds_read_b64 v[74:75], v97 offset:36736
    s_mov_b64 exec, -1
    ds_read_u16 v100, v98 offset:1088
    ds_read_u16 v102, v98 offset:1096
    v_pk_fma_f32 v[88:89], v[14:15], v[92:93], v[90:91]
    v_pk_fma_f32 v[92:93], v[92:93], v[62:63], v[92:93]
    v_pk_fma_f32 v[90:91], v[90:91], v[62:63], v[88:89]
    v_pk_fma_f32 v[88:89], v[12:13], v[92:93], v[90:91]
    v_pk_fma_f32 v[92:93], v[92:93], v[60:61], v[92:93]
    v_pk_fma_f32 v[90:91], v[90:91], v[60:61], v[88:89]
F_YP0_6:
    v_pk_fma_f32 v[88:89], v[10:11], v[92:93], v[90:91]
    v_pk_fma_f32 v[92:93], v[92:93], v[58:59], v[92:93]
    v_pk_fma_f32 v[90:91], v[90:91], v[58:59], v[88:89]
    v_pk_fma_f32 v[88:89], v[8:9], v[92:93], v[90:91]
    v_pk_fma_f32 v[92:93], v[92:93], v[56:57], v[92:93]
    v_pk_fma_f32 v[90:91], v[90:91], v[56:57], v[88:89]
    v_pk_fma_f32 v[88:89], v[6:7], v[92:93], v[90:91]
    v_pk_fma_f32 v[92:93], v[92:93], v[54:55], v[92:93]
    v_pk_fma_f32 v[90:91], v[90:91], v[54:55], v[88:89]
    v_pk_fma_f32 v[88:89], v[4:5], v[92:93], v[90:91]
    v_pk_fma_f32 v[92:93], v[92:93], v[52:53], v[92:93]
    v_pk_fma_f32 v[90:91], v[90:91], v[52:53], v[88:89]
    v_pk_fma_f32 v[88:89], v[2:3], v[92:93], v[90:91]
    v_pk_fma_f32 v[92:93], v[92:93], v[50:51], v[92:93]
    v_pk_fma_f32 v[90:91], v[90:91], v[50:51], v[88:89]
    v_pk_fma_f32 v[88:89], v[0:1], v[92:93], v[90:91]
    v_pk_fma_f32 v[92:93], v[92:93], v[48:49], v[92:93]
    v_pk_fma_f32 v[90:91], v[90:91], v[48:49], v[88:89]
F_L1:
    s_add_u32 s12, s12, s12
    s_waitcnt lgkmcnt(0)
    s_cbranch_scc1 F_SP1
    s_mov_b32 m0, s40
    s_add_u32 s13, s13, s13
    buffer_load_dwordx4 v[100:101], s[24:27], 0 idxen offen sc1 lds
    buffer_load_dwordx4 v[102:103], s[64:67], 0 idxen offen offset:1024 sc1 lds
F_XB1:
    v_mfma_f32_32x32x16_bf16 v[0:15], v[72:75], v[84:87], v[32:47]
    v_exp_f32 v63, v31
    v_exp_f32 v62, v30
    v_exp_f32 v61, v29
    v_exp_f32 v60, v28
    v_exp_f32 v59, v27
    v_exp_f32 v58, v26
    v_exp_f32 v57, v25
    v_exp_f32 v56, v24
    v_exp_f32 v55, v23
    v_exp_f32 v54, v22
    v_smfmac_f32_32x32x32_bf16 v[0:15], v[76:79], v[64:71], v80
    v_exp_f32 v53, v21
    v_exp_f32 v52, v20
    v_exp_f32 v51, v19
    v_exp_f32 v50, v18
    v_exp_f32 v49, v17
    v_exp_f32 v48, v16
    s_waitcnt vmcnt(2)
    ds_read_b64 v[64:65], v99 offset:2048
    ds_read_b64 v[66:67], v99 offset:2560
    ds_read_b64 v[68:69], v99 offset:3072
    ds_read_b64 v[70:71], v99 offset:3584
    s_cbranch_scc1 F_ADVP1
F_RBP1:
    s_mov_b64 exec, s[34:35]
    ds_read_b64 v[72:73], v97 offset:36800
    s_mov_b64 exec, s[36:37]
    ds_read_b64 v[74:75], v97 offset:36800
    s_mov_b64 exec, -1
    ds_read_u16 v100, v98 offset:1104
    ds_read_u16 v102, v98 offset:1112
    v_pk_fma_f32 v[88:89], v[30:31], v[92:93], v[90:91]
    v_pk_fma_f32 v[92:93], v[92:93], v[62:63], v[92:93]
    v_pk_fma_f32 v[90:91], v[90:91], v[62:63], v[88:89]
    v_pk_fma_f32 v[88:89], v[28:29], v[92:93], v[90:91]
    v_pk_fma_f32 v[92:93], v[92:93], v[60:61], v[92:93]
    v_pk_fma_f32 v[90:91], v[90:91], v[60:61], v[88:89]
F_YP1_6:
    v_pk_fma_f32 v[88:89], v[26:27], v[92:93], v[90:91]
    v_pk_fma_f32 v[92:93], v[92:93], v[58:59], v[92:93]
    v_pk_fma_f32 v[90:91], v[90:91], v[58:59], v[88:89]
    v_pk_fma_f32 v[88:89], v[24:25], v[92:93], v[90:91]
    v_pk_fma_f32 v[92:93], v[92:93], v[56:57], v[92:93]
    v_pk_fma_f32 v[90:91], v[90:91], v[56:57], v[88:89]
    v_pk_fma_f32 v[88:89], v[22:23], v[92:93], v[90:91]
    v_pk_fma_f32 v[92:93], v[92:93], v[54:55], v[92:93]
    v_pk_fma_f32 v[90:91], v[90:91], v[54:55], v[88:89]
    v_pk_fma_f32 v[88:89], v[20:21], v[92:93], v[90:91]
    v_pk_fma_f32 v[92:93], v[92:93], v[52:53], v[92:93]
    v_pk_fma_f32 v[90:91], v[90:91], v[52:53], v[88:89]
    v_pk_fma_f32 v[88:89], v[18:19], v[92:93], v[90:91]
    v_pk_fma_f32 v[92:93], v[92:93], v[50:51], v[92:93]
    v_pk_fma_f32 v[90:91], v[90:91], v[50:51], v[88:89]
    v_pk_fma_f32 v[88:89], v[16:17], v[92:93], v[90:91]
    v_pk_fma_f32 v[92:93], v[92:93], v[48:49], v[92:93]
    v_pk_fma_f32 v[90:91], v[90:91], v[48:49], v[88:89]
    s_branch F_L0
K_MAINDONE:
    s_waitcnt vmcnt(0)
    v_lshlrev_b32 v97, 1, v106
    v_cmp_nge_f32 vcc, s63, v96
    v_cmp_u_f32 s[44:45], v94, v95
    global_load_dwordx4 v[0:3], v97, s[60:61] offset:0 sc1
    global_load_dwordx4 v[4:7], v97, s[60:61] offset:1024 sc1
    global_load_dwordx4 v[8:11], v97, s[60:61] offset:2048 sc1
    global_load_dwordx4 v[12:15], v97, s[60:61] offset:3072 sc1
    s_or_b64 vcc, vcc, s[44:45]
    s_cbranch_scc1 K_OVF
K_NOOVF:
    s_waitcnt lgkmcnt(0)
    s_barrier
    ds_read_b64 v[24:25], v106 offset:256
K_CV:
    s_cmp_gt_u32 s48, 39
    s_cbranch_scc1 K_NOCV
    v_lshl_add_u32 v23, s48, 10, v106
    ds_read_b64 v[26:27], v23 offset:52992
    ds_read_b64 v[28:29], v23 offset:53504
    s_mul_i32 s44, s48, 272
    v_xor_b32 v23, s44, v82
    s_add_u32 s48, s48, 16
    s_cmp_lg_u32 s9, 0
    s_waitcnt lgkmcnt(0)
    v_cvt_f32_f64 v26, v[26:27]
    v_cvt_f32_f64 v28, v[28:29]
    v_cvt_pk_bf16_f32 v26, v26, v28
    ds_write_b32 v23, v26 offset:5376
    s_cbranch_scc1 K_CV
K_NOCV:
    s_waitcnt lgkmcnt(0)
    v_readfirstlane_b32 s44, v24
    v_readfirstlane_b32 s45, v25
    s_or_b32 s46, s44, s45
    s_cbranch_scc1 K_SLOW
K_FINAL:
    s_barrier
    s_cmp_ge_u32 s22, 8
    s_cbranch_scc1 K_F1
    ds_read_b128 v[16:19], v120 offset:5376
    ds_read_b128 v[20:23], v121 offset:5376
    ds_read_b128 v[24:27], v122 offset:5376
    ds_read_b128 v[28:31], v123 offset:5376
    ds_read_b128 v[32:35], v120 offset:14080
    ds_read_b128 v[36:39], v121 offset:14080
    ds_read_b128 v[40:43], v122 offset:14080
    ds_read_b128 v[44:47], v123 offset:14080
    s_mov_b32 s46, 0xbfb8aa3b
    s_waitcnt vmcnt(0)
    s_waitcnt lgkmcnt(4)
    v_mfma_f32_16x16x32_bf16 v[112:115], v[0:3], v[16:19], v[112:115]
    v_mfma_f32_16x16x32_bf16 v[112:115], v[4:7], v[20:23], v[112:115]
    v_mfma_f32_16x16x32_bf16 v[112:115], v[8:11], v[24:27], v[112:115]
    v_mfma_f32_16x16x32_bf16 v[112:115], v[12:15], v[28:31], v[112:115]
    s_waitcnt lgkmcnt(0)
    v_mfma_f32_16x16x32_bf16 v[116:119], v[0:3], v[32:35], v[116:119]
    v_mfma_f32_16x16x32_bf16 v[116:119], v[4:7], v[36:39], v[116:119]
    v_mfma_f32_16x16x32_bf16 v[116:119], v[8:11], v[40:43], v[116:119]
    v_mfma_f32_16x16x32_bf16 v[116:119], v[12:15], v[44:47], v[116:119]
    s_nop 2
    v_exp_f32 v64, v112
    v_exp_f32 v65, v113
    v_exp_f32 v66, v114
    v_exp_f32 v67, v115
    v_pk_fma_f32 v[64:65], v[64:65], s[46:47], s[46:47] op_sel_hi:[1,0,0]
    v_pk_fma_f32 v[66:67], v[66:67], s[46:47], s[46:47] op_sel_hi:[1,0,0]
    v_rcp_f32 v64, v64
    v_rcp_f32 v65, v65
    v_rcp_f32 v66, v66
    v_rcp_f32 v67, v67
    v_pk_mul_f32 v[64:65], v[64:65], v[112:113]
    v_pk_mul_f32 v[66:67], v[66:67], v[114:115]
    v_cvt_pk_bf16_f32 v16, v64, v65
    v_cvt_pk_bf16_f32 v17, v66, v67
    ds_write_b64 v124, v[16:17] offset:16128
    v_exp_f32 v64, v116
    v_exp_f32 v65, v117
    v_exp_f32 v66, v118
    v_exp_f32 v67, v119
    v_pk_fma_f32 v[64:65], v[64:65], s[46:47], s[46:47] op_sel_hi:[1,0,0]
    v_pk_fma_f32 v[66:67], v[66:67], s[46:47], s[46:47] op_sel_hi:[1,0,0]
    v_rcp_f32 v64, v64
    v_rcp_f32 v65, v65
    v_rcp_f32 v66, v66
    v_rcp_f32 v67, v67
    v_pk_mul_f32 v[64:65], v[64:65], v[116:117]
    v_pk_mul_f32 v[66:67], v[66:67], v[118:119]
    v_cvt_pk_bf16_f32 v20, v64, v65
    v_cvt_pk_bf16_f32 v21, v66, v67
    ds_write_b64 v124, v[20:21] offset:24320
    s_branch K_OUT
K_F1:
    ds_read_b128 v[16:19], v120 offset:9728
    ds_read_b128 v[20:23], v121 offset:9728
    ds_read_b128 v[24:27], v122 offset:9728
    ds_read_b128 v[28:31], v123 offset:9728
    s_mov_b32 s46, 0xbfb8aa3b
    s_waitcnt vmcnt(0)
    s_waitcnt lgkmcnt(0)
    v_mfma_f32_16x16x32_bf16 v[112:115], v[0:3], v[16:19], v[112:115]
    v_mfma_f32_16x16x32_bf16 v[112:115], v[4:7], v[20:23], v[112:115]
    v_mfma_f32_16x16x32_bf16 v[112:115], v[8:11], v[24:27], v[112:115]
    v_mfma_f32_16x16x32_bf16 v[112:115], v[12:15], v[28:31], v[112:115]
    s_nop 7
    v_exp_f32 v64, v112
    v_exp_f32 v65, v113
    v_exp_f32 v66, v114
    v_exp_f32 v67, v115
    v_pk_fma_f32 v[64:65], v[64:65], s[46:47], s[46:47] op_sel_hi:[1,0,0]
    v_pk_fma_f32 v[66:67], v[66:67], s[46:47], s[46:47] op_sel_hi:[1,0,0]
    v_rcp_f32 v64, v64
    v_rcp_f32 v65, v65
    v_rcp_f32 v66, v66
    v_rcp_f32 v67, v67
    v_pk_mul_f32 v[64:65], v[64:65], v[112:113]
    v_pk_mul_f32 v[66:67], v[66:67], v[114:115]
    v_cvt_pk_bf16_f32 v18, v64, v65
    v_cvt_pk_bf16_f32 v19, v66, v67
    ds_write_b64 v124, v[18:19] offset:20224
K_OUT:
    s_waitcnt lgkmcnt(0)
    s_barrier
    s_cmp_ge_u32 s22, 10
    s_cbranch_scc1 K_END2
    ds_read_b128 v[32:35], v125 offset:16128
    s_waitcnt lgkmcnt(0)
    buffer_store_dwordx4 v[32:35], v83, s[28:31], 0 offen sc1
K_OUT2:
K_END2:
K_END:
    s_endpgm
K_OVF:
    v_mov_b32 v19, 0
    v_mov_b32 v20, 1
    ds_write_b32 v19, v20 offset:260
    s_branch K_NOOVF
K_SHRINK:
    s_mov_b32 s17, 4
    s_mov_b32 s9, 1
    s_mov_b32 s45, 0
    s_branch K_REINIT
K_SLOW:
    s_cmp_eq_u32 s9, 0
    s_cselect_b32 s45, s45, 0
    s_or_b32 s44, s44, s45
    s_cbranch_scc0 K_FINAL
    s_cmp_eq_u32 s45, 0
    s_cselect_b32 s44, s17, 0
    s_add_u32 s8, s8, s44
K_REINIT:
    s_waitcnt vmcnt(0) lgkmcnt(0)
    s_barrier
    v_lshrrev_b32 v9, 1, v106
    v_mov_b32 v10, 0
    ds_write_b32 v9, v10 offset:0
    ds_write_b32 v9, v10 offset:512
    ds_write_b32 v10, v10 offset:256
    ds_write_b32 v10, v10 offset:260
    v_lshlrev_b32 v9, 2, v108
    v_mov_b32 v10, -1
    ds_write_b32 v9, v10 offset:1024
    s_cmp_eq_u32 s45, 0
    s_cbranch_scc1 K_SLOW1
    s_mov_b32 s9, 1
    v_lshlrev_b32 v9, 4, v108
    v_add_u32 v9, 52992, v9
    v_mov_b64 v[4:5], 0
    v_mov_b64 v[6:7], 0
    ds_write_b128 v9, v[4:7]
    ds_write_b128 v9, v[4:7] offset:16384
    ds_write_b128 v9, v[4:7] offset:24576
K_SLOW1:
    v_and_b32 v22, 3, v108
    s_waitcnt lgkmcnt(0)
    s_barrier
    s_branch K_PASS
S_START:
    v_mov_b64 v[92:93], s[38:39]
    v_mov_b64 v[90:91], 0
    s_waitcnt lgkmcnt(1)
    s_mov_b32 m0, s40
    s_nop 0
    buffer_load_dwordx4 v[100:101], s[24:27], 0 idxen offen sc1 lds
    buffer_load_dwordx4 v[102:103], s[64:67], 0 idxen offen offset:1024 sc1 lds
    ds_read_u16 v100, v98 offset:1040
    ds_read_u16 v102, v98 offset:1048
    v_lshl_add_u32 v104, s16, 9, v106
    ds_read_b64 v[32:33], v104 offset:16128
    ds_read_b64 v[34:35], v104 offset:16128
    ds_read_b64 v[36:37], v104 offset:16128
    ds_read_b64 v[38:39], v104 offset:16128
    ds_read_b64 v[40:41], v104 offset:16128
    ds_read_b64 v[42:43], v104 offset:16128
    ds_read_b64 v[44:45], v104 offset:16128
    ds_read_b64 v[46:47], v104 offset:16128
    s_waitcnt lgkmcnt(8)
    v_cmp_ne_u32 vcc, 0, v16
    s_mov_b32 m0, s41
    s_nop 0
    buffer_load_dwordx4 v[100:101], s[24:27], 0 idxen offen sc1 lds
    buffer_load_dwordx4 v[102:103], s[64:67], 0 idxen offen offset:1024 sc1 lds
    ds_read_u16 v100, v98 offset:1056
    ds_read_u16 v102, v98 offset:1064
    s_mov_b64 exec, s[34:35]
    ds_read_b64 v[72:73], v97 offset:36608
    s_mov_b64 exec, s[36:37]
    ds_read_b64 v[74:75], v97 offset:36608
    s_mov_b64 exec, -1
    s_brev_b32 s12, vcc_lo
    s_lshl_b32 s13, s12, 1
    s_sub_u32 s44, 32, s10
    s_lshr_b32 s14, s12, s44
    s_lshl_b32 s12, s14, s44
    s_sub_u32 s44, s44, 1
    s_lshl_b32 s44, 79, s44
    s_or_b32 s12, s12, s44
    s_waitcnt vmcnt(2)
    ds_read_b64 v[64:65], v99 offset:0
    ds_read_b64 v[66:67], v99 offset:512
    ds_read_b64 v[68:69], v99 offset:1024
    ds_read_b64 v[70:71], v99 offset:1536
    s_waitcnt lgkmcnt(0)
    s_mov_b32 m0, s40
    s_nop 0
    buffer_load_dwordx4 v[100:101], s[24:27], 0 idxen offen sc1 lds
    buffer_load_dwordx4 v[102:103], s[64:67], 0 idxen offen offset:1024 sc1 lds
    v_mfma_f32_32x32x16_bf16 v[0:15], v[72:75], v[84:87], v[32:47]
    v_smfmac_f32_32x32x32_bf16 v[0:15], v[76:79], v[64:71], v80
    s_mov_b64 exec, s[34:35]
    ds_read_b64 v[72:73], v97 offset:36672
    s_mov_b64 exec, s[36:37]
    ds_read_b64 v[74:75], v97 offset:36672
    s_mov_b64 exec, -1
    ds_read_u16 v100, v98 offset:1072
    ds_read_u16 v102, v98 offset:1080
    s_bitcmp0_b32 vcc_lo, 0
    s_cbranch_scc1 S_S4
    s_bitset0_b64 s[32:33], s16
    s_ff1_i32_b64 s16, s[32:33]
    v_lshl_add_u32 v104, s16, 9, v106
    ds_read_b64 v[32:33], v104 offset:16128
    ds_read_b64 v[34:35], v104 offset:16128
    ds_read_b64 v[36:37], v104 offset:16128
    ds_read_b64 v[38:39], v104 offset:16128
    ds_read_b64 v[40:41], v104 offset:16128
    ds_read_b64 v[42:43], v104 offset:16128
    ds_read_b64 v[44:45], v104 offset:16128
    ds_read_b64 v[46:47], v104 offset:16128
S_S4:
    s_waitcnt vmcnt(2)
    ds_read_b64 v[64:65], v99 offset:2048
    ds_read_b64 v[66:67], v99 offset:2560
    ds_read_b64 v[68:69], v99 offset:3072
    ds_read_b64 v[70:71], v99 offset:3584
    s_branch S_L0B
S_TAIL0:
    s_setprio 2
    s_cmp_ge_u32 s10, 3
    s_cbranch_scc1 S_TD0
    s_setprio 1
    s_cmp_gt_u32 s10, 0
    s_cbranch_scc1 S_T10
    s_setprio 0
S_T10:
    s_waitcnt vmcnt(0)
    s_branch S_T20
S_TD0:
    s_mov_b32 m0, s41
    s_nop 0
    buffer_load_dwordx4 v[100:101], s[24:27], 0 idxen offen sc1 lds
    buffer_load_dwordx4 v[102:103], s[64:67], 0 idxen offen offset:1024 sc1 lds
S_T20:
    s_bitcmp1_b32 s14, s10
    s_cbranch_scc1 S_ENDN0
    s_cmp_eq_u32 s10, 0
    s_cbranch_scc1 S_RE0
    s_add_u32 s13, s13, s13
    s_branch S_XB0
S_RE0:
    s_mov_b32 s11, 8
    s_mov_b32 s69, s15
    s_mov_b32 s68, 1
    s_branch S_X0_8
S_ADVP0:
    s_bitset0_b64 s[32:33], s16
    s_ff1_i32_b64 s16, s[32:33]
    v_lshl_add_u32 v104, s16, 9, v106
    ds_read_b64 v[32:33], v104 offset:16128
    ds_read_b64 v[34:35], v104 offset:16128
    ds_read_b64 v[36:37], v104 offset:16128
    ds_read_b64 v[38:39], v104 offset:16128
    ds_read_b64 v[40:41], v104 offset:16128
    ds_read_b64 v[42:43], v104 offset:16128
    ds_read_b64 v[44:45], v104 offset:16128
    ds_read_b64 v[46:47], v104 offset:16128
    s_branch S_RBP0
S_ADVE0:
    s_bitset0_b64 s[32:33], s16
    s_ff1_i32_b64 s16, s[32:33]
    v_lshl_add_u32 v104, s16, 9, v106
    ds_read_b64 v[32:33], v104 offset:16128
    ds_read_b64 v[34:35], v104 offset:16128
    ds_read_b64 v[36:37], v104 offset:16128
    ds_read_b64 v[38:39], v104 offset:16128
    ds_read_b64 v[40:41], v104 offset:16128
    ds_read_b64 v[42:43], v104 offset:16128
    ds_read_b64 v[44:45], v104 offset:16128
    ds_read_b64 v[46:47], v104 offset:16128
    s_branch S_RBE0
S_XD0:
    s_cmp_gt_u32 s11, 3
    s_cbranch_scc1 S_XD0_H
    s_cmp_eq_u32 s11, 2
    s_cbranch_scc1 S_XS0_2
    s_cmp_eq_u32 s11, 3
    s_cbranch_scc1 S_XS0_3
    s_branch S_XS0_1
S_XD0_H:
    s_cmp_gt_u32 s11, 5
    s_cbranch_scc1 S_XD0_HH
    s_cmp_eq_u32 s11, 4
    s_cbranch_scc1 S_XS0_4
    s_branch S_XS0_5
S_XD0_HH:
    s_cmp_eq_u32 s11, 6
    s_cbranch_scc1 S_XS0_6
    s_branch S_XS0_7
S_XS0_1:
    v_mfma_f32_32x32x16_bf16 v[16:31], v[72:75], v[84:87], v[32:47]
    v_smfmac_f32_32x32x32_bf16 v[16:31], v[76:79], v[64:71], v80
    s_branch S_X0_1
S_XS0_2:
    v_mfma_f32_32x32x16_bf16 v[16:31], v[72:75], v[84:87], v[32:47]
    v_smfmac_f32_32x32x32_bf16 v[16:31], v[76:79], v[64:71], v80
    s_branch S_X0_2
S_XS0_3:
    v_mfma_f32_32x32x16_bf16 v[16:31], v[72:75], v[84:87], v[32:47]
    s_branch S_X0_3
S_XS0_4:
    v_mfma_f32_32x32x16_bf16 v[16:31], v[72:75], v[84:87], v[32:47]
    s_branch S_X0_4
S_XS0_5:
    v_mfma_f32_32x32x16_bf16 v[16:31], v[72:75], v[84:87], v[32:47]
    s_branch S_X0_5
S_XS0_6:
    v_mfma_f32_32x32x16_bf16 v[16:31], v[72:75], v[84:87], v[32:47]
    s_branch S_X0_6
S_XS0_7:
    v_mfma_f32_32x32x16_bf16 v[16:31], v[72:75], v[84:87], v[32:47]
    s_branch S_X0_7
S_YD0:
    s_cmp_gt_u32 s11, 3
    s_cbranch_scc1 S_YD0_H
    s_cmp_eq_u32 s11, 2
    s_cbranch_scc1 S_Y0_2
    s_cmp_eq_u32 s11, 3
    s_cbranch_scc1 S_Y0_3
    s_branch S_Y0_1
S_YD0_H:
    s_cmp_gt_u32 s11, 5
    s_cbranch_scc1 S_YD0_HH
    s_cmp_eq_u32 s11, 4
    s_cbranch_scc1 S_Y0_4
    s_branch S_Y0_5
S_YD0_HH:
    s_cmp_eq_u32 s11, 6
    s_cbranch_scc1 S_Y0_6
    s_branch S_Y0_7
S_SP0:
    s_ff1_i32_b32 s10, s12
    s_sub_u32 s10, 31, s10
    s_cmp_le_u32 s10, 5
    s_cbranch_scc1 S_TAIL0
    s_mov_b32 m0, s41
    s_nop 0
    buffer_load_dwordx4 v[100:101], s[24:27], 0 idxen offen sc1 lds
    buffer_load_dwordx4 v[102:103], s[64:67], 0 idxen offen offset:1024 sc1 lds
S_ENDN0:
    v_readlane_b32 s11, v107, s15
    s_mov_b32 s69, s15
    s_bitset0_b64 s[18:19], s15
    s_ff1_i32_b64 s15, s[18:19]
    s_cmp_lt_u32 s11, 8
    s_cbranch_scc1 S_XD0
S_X0_8:
    v_mfma_f32_32x32x16_bf16 v[16:31], v[72:75], v[84:87], v[32:47]
    v_exp_f32 v63, v15
    v_exp_f32 v62, v14
S_X0_7:
    v_exp_f32 v61, v13
    v_exp_f32 v60, v12
S_X0_6:
    v_exp_f32 v59, v11
    v_exp_f32 v58, v10
S_X0_5:
    v_exp_f32 v57, v9
    v_exp_f32 v56, v8
S_X0_4:
    v_exp_f32 v55, v7
    v_exp_f32 v54, v6
S_X0_3:
    v_smfmac_f32_32x32x32_bf16 v[16:31], v[76:79], v[64:71], v80
    v_exp_f32 v53, v5
    v_exp_f32 v52, v4
S_X0_2:
    v_exp_f32 v51, v3
    v_exp_f32 v50, v2
S_X0_1:
    v_exp_f32 v49, v1
    v_exp_f32 v48, v0
    s_waitcnt vmcnt(2)
    ds_read_b64 v[64:65], v99 offset:0
    ds_read_b64 v[66:67], v99 offset:512
    ds_read_b64 v[68:69], v99 offset:1024
    ds_read_b64 v[70:71], v99 offset:1536
    s_add_u32 s13, s13, s13
    s_cbranch_scc1 S_ADVE0
S_RBE0:
    s_mov_b64 exec, s[34:35]
    ds_read_b64 v[72:73], v97 offset:36736
    s_mov_b64 exec, s[36:37]
    ds_read_b64 v[74:75], v97 offset:36736
    s_mov_b64 exec, -1
    ds_read_u16 v100, v98 offset:1088
    ds_read_u16 v102, v98 offset:1096
    s_cmp_lt_u32 s11, 8
    s_cbranch_scc1 S_YD0
    v_pk_add_f32 v[62:63], v[62:63], 1.0 op_sel_hi:[1,0]
    v_rcp_f32 v62, v62
    v_rcp_f32 v63, v63
    s_nop 0
    v_pk_fma_f32 v[90:91], v[14:15], v[62:63], v[90:91]
S_Y0_7:
    v_pk_add_f32 v[60:61], v[60:61], 1.0 op_sel_hi:[1,0]
    v_rcp_f32 v60, v60
    v_rcp_f32 v61, v61
    s_nop 0
    v_pk_fma_f32 v[90:91], v[12:13], v[60:61], v[90:91]
S_Y0_6:
    v_pk_add_f32 v[58:59], v[58:59], 1.0 op_sel_hi:[1,0]
    v_rcp_f32 v58, v58
    v_rcp_f32 v59, v59
    s_nop 0
    v_pk_fma_f32 v[90:91], v[10:11], v[58:59], v[90:91]
S_Y0_5:
    v_pk_add_f32 v[56:57], v[56:57], 1.0 op_sel_hi:[1,0]
    v_rcp_f32 v56, v56
    v_rcp_f32 v57, v57
    s_nop 0
    v_pk_fma_f32 v[90:91], v[8:9], v[56:57], v[90:91]
S_Y0_4:
    v_pk_add_f32 v[54:55], v[54:55], 1.0 op_sel_hi:[1,0]
    v_rcp_f32 v54, v54
    v_rcp_f32 v55, v55
    s_nop 0
    v_pk_fma_f32 v[90:91], v[6:7], v[54:55], v[90:91]
S_Y0_3:
    v_pk_add_f32 v[52:53], v[52:53], 1.0 op_sel_hi:[1,0]
    v_rcp_f32 v52, v52
    v_rcp_f32 v53, v53
    s_nop 0
    v_pk_fma_f32 v[90:91], v[4:5], v[52:53], v[90:91]
S_Y0_2:
    v_pk_add_f32 v[50:51], v[50:51], 1.0 op_sel_hi:[1,0]
    v_rcp_f32 v50, v50
    v_rcp_f32 v51, v51
    s_nop 0
    v_pk_fma_f32 v[90:91], v[2:3], v[50:51], v[90:91]
S_Y0_1:
    v_pk_add_f32 v[48:49], v[48:49], 1.0 op_sel_hi:[1,0]
    v_rcp_f32 v48, v48
    v_rcp_f32 v49, v49
    s_nop 0
    v_pk_fma_f32 v[90:91], v[0:1], v[48:49], v[90:91]
    v_lshl_add_u32 v105, s69, 10, v106
    v_cvt_f64_f32 v[48:49], v90
    v_cvt_f64_f32 v[50:51], v91
    v_mov_b64 v[90:91], 0
    ds_add_f64 v105, v[48:49] offset:52992
    ds_add_f64 v105, v[50:51] offset:53504
    s_cmp_eq_u32 s10, 0
    s_cbranch_scc1 K_MAINDONE
    s_branch S_L1
S_TAIL1:
    s_setprio 2
    s_cmp_ge_u32 s10, 3
    s_cbranch_scc1 S_TD1
    s_setprio 1
    s_cmp_gt_u32 s10, 0
    s_cbranch_scc1 S_T11
    s_setprio 0
S_T11:
    s_waitcnt vmcnt(0)
    s_branch S_T21
S_TD1:
    s_mov_b32 m0, s40
    s_nop 0
    buffer_load_dwordx4 v[100:101], s[24:27], 0 idxen offen sc1 lds
    buffer_load_dwordx4 v[102:103], s[64:67], 0 idxen offen offset:1024 sc1 lds
S_T21:
    s_bitcmp1_b32 s14, s10
    s_cbranch_scc1 S_ENDN1
    s_cmp_eq_u32 s10, 0
    s_cbranch_scc1 S_RE1
    s_add_u32 s13, s13, s13
    s_branch S_XB1
S_RE1:
    s_mov_b32 s11, 8
    s_mov_b32 s69, s15
    s_mov_b32 s68, 1
    s_branch S_X1_8
S_ADVP1:
    s_bitset0_b64 s[32:33], s16
    s_ff1_i32_b64 s16, s[32:33]
    v_lshl_add_u32 v104, s16, 9, v106
    ds_read_b64 v[32:33], v104 offset:16128
    ds_read_b64 v[34:35], v104 offset:16128
    ds_read_b64 v[36:37], v104 offset:16128
    ds_read_b64 v[38:39], v104 offset:16128
    ds_read_b64 v[40:41], v104 offset:16128
    ds_read_b64 v[42:43], v104 offset:16128
    ds_read_b64 v[44:45], v104 offset:16128
    ds_read_b64 v[46:47], v104 offset:16128
    s_branch S_RBP1
S_ADVE1:
    s_bitset0_b64 s[32:33], s16
    s_ff1_i32_b64 s16, s[32:33]
    v_lshl_add_u32 v104, s16, 9, v106
    ds_read_b64 v[32:33], v104 offset:16128
    ds_read_b64 v[34:35], v104 offset:16128
    ds_read_b64 v[36:37], v104 offset:16128
    ds_read_b64 v[38:39], v104 offset:16128
    ds_read_b64 v[40:41], v104 offset:16128
    ds_read_b64 v[42:43], v104 offset:16128
    ds_read_b64 v[44:45], v104 offset:16128
    ds_read_b64 v[46:47], v104 offset:16128
    s_branch S_RBE1
S_XD1:
    s_cmp_gt_u32 s11, 3
    s_cbranch_scc1 S_XD1_H
    s_cmp_eq_u32 s11, 2
    s_cbranch_scc1 S_XS1_2
    s_cmp_eq_u32 s11, 3
    s_cbranch_scc1 S_XS1_3
    s_branch S_XS1_1
S_XD1_H:
    s_cmp_gt_u32 s11, 5
    s_cbranch_scc1 S_XD1_HH
    s_cmp_eq_u32 s11, 4
    s_cbranch_scc1 S_XS1_4
    s_branch S_XS1_5
S_XD1_HH:
    s_cmp_eq_u32 s11, 6
    s_cbranch_scc1 S_XS1_6
    s_branch S_XS1_7
S_XS1_1:
    v_mfma_f32_32x32x16_bf16 v[0:15], v[72:75], v[84:87], v[32:47]
    v_smfmac_f32_32x32x32_bf16 v[0:15], v[76:79], v[64:71], v80
    s_branch S_X1_1
S_XS1_2:
    v_mfma_f32_32x32x16_bf16 v[0:15], v[72:75], v[84:87], v[32:47]
    v_smfmac_f32_32x32x32_bf16 v[0:15], v[76:79], v[64:71], v80
    s_branch S_X1_2
S_XS1_3:
    v_mfma_f32_32x32x16_bf16 v[0:15], v[72:75], v[84:87], v[32:47]
    s_branch S_X1_3
S_XS1_4:
    v_mfma_f32_32x32x16_bf16 v[0:15], v[72:75], v[84:87], v[32:47]
    s_branch S_X1_4
S_XS1_5:
    v_mfma_f32_32x32x16_bf16 v[0:15], v[72:75], v[84:87], v[32:47]
    s_branch S_X1_5
S_XS1_6:
    v_mfma_f32_32x32x16_bf16 v[0:15], v[72:75], v[84:87], v[32:47]
    s_branch S_X1_6
S_XS1_7:
    v_mfma_f32_32x32x16_bf16 v[0:15], v[72:75], v[84:87], v[32:47]
    s_branch S_X1_7
S_YD1:
    s_cmp_gt_u32 s11, 3
    s_cbranch_scc1 S_YD1_H
    s_cmp_eq_u32 s11, 2
    s_cbranch_scc1 S_Y1_2
    s_cmp_eq_u32 s11, 3
    s_cbranch_scc1 S_Y1_3
    s_branch S_Y1_1
S_YD1_H:
    s_cmp_gt_u32 s11, 5
    s_cbranch_scc1 S_YD1_HH
    s_cmp_eq_u32 s11, 4
    s_cbranch_scc1 S_Y1_4
    s_branch S_Y1_5
S_YD1_HH:
    s_cmp_eq_u32 s11, 6
    s_cbranch_scc1 S_Y1_6
    s_branch S_Y1_7
S_SP1:
    s_ff1_i32_b32 s10, s12
    s_sub_u32 s10, 31, s10
    s_cmp_le_u32 s10, 5
    s_cbranch_scc1 S_TAIL1
    s_mov_b32 m0, s40
    s_nop 0
    buffer_load_dwordx4 v[100:101], s[24:27], 0 idxen offen sc1 lds
    buffer_load_dwordx4 v[102:103], s[64:67], 0 idxen offen offset:1024 sc1 lds
S_ENDN1:
    v_readlane_b32 s11, v107, s15
    s_mov_b32 s69, s15
    s_bitset0_b64 s[18:19], s15
    s_ff1_i32_b64 s15, s[18:19]
    s_cmp_lt_u32 s11, 8
    s_cbranch_scc1 S_XD1
S_X1_8:
    v_mfma_f32_32x32x16_bf16 v[0:15], v[72:75], v[84:87], v[32:47]
    v_exp_f32 v63, v31
    v_exp_f32 v62, v30
S_X1_7:
    v_exp_f32 v61, v29
    v_exp_f32 v60, v28
S_X1_6:
    v_exp_f32 v59, v27
    v_exp_f32 v58, v26
S_X1_5:
    v_exp_f32 v57, v25
    v_exp_f32 v56, v24
S_X1_4:
    v_exp_f32 v55, v23
    v_exp_f32 v54, v22
S_X1_3:
    v_smfmac_f32_32x32x32_bf16 v[0:15], v[76:79], v[64:71], v80
    v_exp_f32 v53, v21
    v_exp_f32 v52, v20
S_X1_2:
    v_exp_f32 v51, v19
    v_exp_f32 v50, v18
S_X1_1:
    v_exp_f32 v49, v17
    v_exp_f32 v48, v16
    s_waitcnt vmcnt(2)
    ds_read_b64 v[64:65], v99 offset:2048
    ds_read_b64 v[66:67], v99 offset:2560
    ds_read_b64 v[68:69], v99 offset:3072
    ds_read_b64 v[70:71], v99 offset:3584
    s_add_u32 s13, s13, s13
    s_cbranch_scc1 S_ADVE1
S_RBE1:
    s_mov_b64 exec, s[34:35]
    ds_read_b64 v[72:73], v97 offset:36800
    s_mov_b64 exec, s[36:37]
    ds_read_b64 v[74:75], v97 offset:36800
    s_mov_b64 exec, -1
    ds_read_u16 v100, v98 offset:1104
    ds_read_u16 v102, v98 offset:1112
    s_cmp_lt_u32 s11, 8
    s_cbranch_scc1 S_YD1
    v_pk_add_f32 v[62:63], v[62:63], 1.0 op_sel_hi:[1,0]
    v_rcp_f32 v62, v62
    v_rcp_f32 v63, v63
    s_nop 0
    v_pk_fma_f32 v[90:91], v[30:31], v[62:63], v[90:91]
S_Y1_7:
    v_pk_add_f32 v[60:61], v[60:61], 1.0 op_sel_hi:[1,0]
    v_rcp_f32 v60, v60
    v_rcp_f32 v61, v61
    s_nop 0
    v_pk_fma_f32 v[90:91], v[28:29], v[60:61], v[90:91]
S_Y1_6:
    v_pk_add_f32 v[58:59], v[58:59], 1.0 op_sel_hi:[1,0]
    v_rcp_f32 v58, v58
    v_rcp_f32 v59, v59
    s_nop 0
    v_pk_fma_f32 v[90:91], v[26:27], v[58:59], v[90:91]
S_Y1_5:
    v_pk_add_f32 v[56:57], v[56:57], 1.0 op_sel_hi:[1,0]
    v_rcp_f32 v56, v56
    v_rcp_f32 v57, v57
    s_nop 0
    v_pk_fma_f32 v[90:91], v[24:25], v[56:57], v[90:91]
S_Y1_4:
    v_pk_add_f32 v[54:55], v[54:55], 1.0 op_sel_hi:[1,0]
    v_rcp_f32 v54, v54
    v_rcp_f32 v55, v55
    s_nop 0
    v_pk_fma_f32 v[90:91], v[22:23], v[54:55], v[90:91]
S_Y1_3:
    v_pk_add_f32 v[52:53], v[52:53], 1.0 op_sel_hi:[1,0]
    v_rcp_f32 v52, v52
    v_rcp_f32 v53, v53
    s_nop 0
    v_pk_fma_f32 v[90:91], v[20:21], v[52:53], v[90:91]
S_Y1_2:
    v_pk_add_f32 v[50:51], v[50:51], 1.0 op_sel_hi:[1,0]
    v_rcp_f32 v50, v50
    v_rcp_f32 v51, v51
    s_nop 0
    v_pk_fma_f32 v[90:91], v[18:19], v[50:51], v[90:91]
S_Y1_1:
    v_pk_add_f32 v[48:49], v[48:49], 1.0 op_sel_hi:[1,0]
    v_rcp_f32 v48, v48
    v_rcp_f32 v49, v49
    s_nop 0
    v_pk_fma_f32 v[90:91], v[16:17], v[48:49], v[90:91]
    v_lshl_add_u32 v105, s69, 10, v106
    v_cvt_f64_f32 v[48:49], v90
    v_cvt_f64_f32 v[50:51], v91
    v_mov_b64 v[90:91], 0
    ds_add_f64 v105, v[48:49] offset:52992
    ds_add_f64 v105, v[50:51] offset:53504
    s_cmp_eq_u32 s10, 0
    s_cbranch_scc1 K_MAINDONE
    s_branch S_L0
    .p2align 6
S_L0:
    v_add_u32 v97, 128, v97
    v_add_u32 v98, 32, v98
S_L0B:
    s_add_u32 s12, s12, s12
    s_waitcnt lgkmcnt(0)
    s_cbranch_scc1 S_SP0
    s_mov_b32 m0, s41
    s_add_u32 s13, s13, s13
    buffer_load_dwordx4 v[100:101], s[24:27], 0 idxen offen sc1 lds
    buffer_load_dwordx4 v[102:103], s[64:67], 0 idxen offen offset:1024 sc1 lds
S_XB0:
    v_mfma_f32_32x32x16_bf16 v[16:31], v[72:75], v[84:87], v[32:47]
    v_exp_f32 v63, v15
    v_exp_f32 v62, v14
    v_exp_f32 v61, v13
    v_exp_f32 v60, v12
    v_exp_f32 v59, v11
    v_exp_f32 v58, v10
    v_exp_f32 v57, v9
    v_exp_f32 v56, v8
    v_exp_f32 v55, v7
    v_exp_f32 v54, v6
    v_smfmac_f32_32x32x32_bf16 v[16:31], v[76:79], v[64:71], v80
    v_exp_f32 v53, v5
    v_exp_f32 v52, v4
    v_exp_f32 v51, v3
    v_exp_f32 v50, v2
    v_exp_f32 v49, v1
    v_exp_f32 v48, v0
    s_waitcnt vmcnt(2)
    ds_read_b64 v[64:65], v99 offset:0
    ds_read_b64 v[66:67], v99 offset:512
    ds_read_b64 v[68:69], v99 offset:1024
    ds_read_b64 v[70:71], v99 offset:1536
    s_cbranch_scc1 S_ADVP0
S_RBP0:
    s_mov_b64 exec, s[34:35]
    ds_read_b64 v[72:73], v97 offset:36736
    s_mov_b64 exec, s[36:37]
    ds_read_b64 v[74:75], v97 offset:36736
    s_mov_b64 exec, -1
    ds_read_u16 v100, v98 offset:1088
    ds_read_u16 v102, v98 offset:1096
    v_pk_add_f32 v[62:63], v[62:63], 1.0 op_sel_hi:[1,0]
    v_rcp_f32 v62, v62
    v_rcp_f32 v63, v63
    s_nop 0
    v_pk_fma_f32 v[90:91], v[14:15], v[62:63], v[90:91]
    v_pk_add_f32 v[60:61], v[60:61], 1.0 op_sel_hi:[1,0]
    v_rcp_f32 v60, v60
    v_rcp_f32 v61, v61
    s_nop 0
    v_pk_fma_f32 v[90:91], v[12:13], v[60:61], v[90:91]
S_YP0_6:
    v_pk_add_f32 v[58:59], v[58:59], 1.0 op_sel_hi:[1,0]
    v_rcp_f32 v58, v58
    v_rcp_f32 v59, v59
    s_nop 0
    v_pk_fma_f32 v[90:91], v[10:11], v[58:59], v[90:91]
    v_pk_add_f32 v[56:57], v[56:57], 1.0 op_sel_hi:[1,0]
    v_rcp_f32 v56, v56
    v_rcp_f32 v57, v57
    s_nop 0
    v_pk_fma_f32 v[90:91], v[8:9], v[56:57], v[90:91]
    v_pk_add_f32 v[54:55], v[54:55], 1.0 op_sel_hi:[1,0]
    v_rcp_f32 v54, v54
    v_rcp_f32 v55, v55
    s_nop 0
    v_pk_fma_f32 v[90:91], v[6:7], v[54:55], v[90:91]
    v_pk_add_f32 v[52:53], v[52:53], 1.0 op_sel_hi:[1,0]
    v_rcp_f32 v52, v52
    v_rcp_f32 v53, v53
    s_nop 0
    v_pk_fma_f32 v[90:91], v[4:5], v[52:53], v[90:91]
    v_pk_add_f32 v[50:51], v[50:51], 1.0 op_sel_hi:[1,0]
    v_rcp_f32 v50, v50
    v_rcp_f32 v51, v51
    s_nop 0
    v_pk_fma_f32 v[90:91], v[2:3], v[50:51], v[90:91]
    v_pk_add_f32 v[48:49], v[48:49], 1.0 op_sel_hi:[1,0]
    v_rcp_f32 v48, v48
    v_rcp_f32 v49, v49
    s_nop 0
    v_pk_fma_f32 v[90:91], v[0:1], v[48:49], v[90:91]
S_L1:
    s_add_u32 s12, s12, s12
    s_waitcnt lgkmcnt(0)
    s_cbranch_scc1 S_SP1
    s_mov_b32 m0, s40
    s_add_u32 s13, s13, s13
    buffer_load_dwordx4 v[100:101], s[24:27], 0 idxen offen sc1 lds
    buffer_load_dwordx4 v[102:103], s[64:67], 0 idxen offen offset:1024 sc1 lds
S_XB1:
    v_mfma_f32_32x32x16_bf16 v[0:15], v[72:75], v[84:87], v[32:47]
    v_exp_f32 v63, v31
    v_exp_f32 v62, v30
    v_exp_f32 v61, v29
    v_exp_f32 v60, v28
    v_exp_f32 v59, v27
    v_exp_f32 v58, v26
    v_exp_f32 v57, v25
    v_exp_f32 v56, v24
    v_exp_f32 v55, v23
    v_exp_f32 v54, v22
    v_smfmac_f32_32x32x32_bf16 v[0:15], v[76:79], v[64:71], v80
    v_exp_f32 v53, v21
    v_exp_f32 v52, v20
    v_exp_f32 v51, v19
    v_exp_f32 v50, v18
    v_exp_f32 v49, v17
    v_exp_f32 v48, v16
    s_waitcnt vmcnt(2)
    ds_read_b64 v[64:65], v99 offset:2048
    ds_read_b64 v[66:67], v99 offset:2560
    ds_read_b64 v[68:69], v99 offset:3072
    ds_read_b64 v[70:71], v99 offset:3584
    s_cbranch_scc1 S_ADVP1
S_RBP1:
    s_mov_b64 exec, s[34:35]
    ds_read_b64 v[72:73], v97 offset:36800
    s_mov_b64 exec, s[36:37]
    ds_read_b64 v[74:75], v97 offset:36800
    s_mov_b64 exec, -1
    ds_read_u16 v100, v98 offset:1104
    ds_read_u16 v102, v98 offset:1112
    v_pk_add_f32 v[62:63], v[62:63], 1.0 op_sel_hi:[1,0]
    v_rcp_f32 v62, v62
    v_rcp_f32 v63, v63
    s_nop 0
    v_pk_fma_f32 v[90:91], v[30:31], v[62:63], v[90:91]
    v_pk_add_f32 v[60:61], v[60:61], 1.0 op_sel_hi:[1,0]
    v_rcp_f32 v60, v60
    v_rcp_f32 v61, v61
    s_nop 0
    v_pk_fma_f32 v[90:91], v[28:29], v[60:61], v[90:91]
S_YP1_6:
    v_pk_add_f32 v[58:59], v[58:59], 1.0 op_sel_hi:[1,0]
    v_rcp_f32 v58, v58
    v_rcp_f32 v59, v59
    s_nop 0
    v_pk_fma_f32 v[90:91], v[26:27], v[58:59], v[90:91]
    v_pk_add_f32 v[56:57], v[56:57], 1.0 op_sel_hi:[1,0]
    v_rcp_f32 v56, v56
    v_rcp_f32 v57, v57
    s_nop 0
    v_pk_fma_f32 v[90:91], v[24:25], v[56:57], v[90:91]
    v_pk_add_f32 v[54:55], v[54:55], 1.0 op_sel_hi:[1,0]
    v_rcp_f32 v54, v54
    v_rcp_f32 v55, v55
    s_nop 0
    v_pk_fma_f32 v[90:91], v[22:23], v[54:55], v[90:91]
    v_pk_add_f32 v[52:53], v[52:53], 1.0 op_sel_hi:[1,0]
    v_rcp_f32 v52, v52
    v_rcp_f32 v53, v53
    s_nop 0
    v_pk_fma_f32 v[90:91], v[20:21], v[52:53], v[90:91]
    v_pk_add_f32 v[50:51], v[50:51], 1.0 op_sel_hi:[1,0]
    v_rcp_f32 v50, v50
    v_rcp_f32 v51, v51
    s_nop 0
    v_pk_fma_f32 v[90:91], v[18:19], v[50:51], v[90:91]
    v_pk_add_f32 v[48:49], v[48:49], 1.0 op_sel_hi:[1,0]
    v_rcp_f32 v48, v48
    v_rcp_f32 v49, v49
    s_nop 0
    v_pk_fma_f32 v[90:91], v[16:17], v[48:49], v[90:91]
    s_branch S_L0
.section .rodata,"a"
.p2align 6
.amdhsa_kernel gather_scatter__mpnn_edge_mlp__graph_kernel
  .amdhsa_next_free_vgpr 128
  .amdhsa_next_free_sgpr 72
  .amdhsa_accum_offset 128
  .amdhsa_group_segment_fixed_size 0
  .amdhsa_kernarg_size 72
  .amdhsa_user_sgpr_count 2
  .amdhsa_user_sgpr_kernarg_segment_ptr 1
  .amdhsa_system_sgpr_workgroup_id_x 1
.end_amdhsa_kernel
```
